```python
import torch

def _softmax(x, axis=-1):
    return torch.softmax(x, dim=axis)
def _gelu(x):
    return torch.nn.functional.gelu(x, approximate="tanh")
def _silu(x):
    return torch.nn.functional.silu(x)
def _sigmoid(x):
    return torch.sigmoid(x)
def _layernorm(x, axis=-1, eps=1e-5):
    m = x.mean(dim=axis, keepdim=True)
    v = x.var(dim=axis, keepdim=True, unbiased=False)
    return (x - m) / torch.sqrt(v + eps)
def _scatter_add(tgt, idx, src, axis=0):
    return tgt.clone().index_add_(axis, idx, src)
def _segment_sum(src, seg, n):
    out = torch.zeros((n,) + src.shape[1:], dtype=src.dtype)
    return out.index_add_(0, seg, src)
def _pad(x, pw):
    flat = tuple(v for pair in reversed(pw) for v in pair)
    return torch.nn.functional.pad(x, flat)

kernel_name = 'standalone__gqa_block_cached__decode'

def setup_inputs():

    _w = (lambda a: (lambda t: t.to(torch.bfloat16) if t.is_floating_point() else t)(torch.as_tensor(a)))
    B, Sq, D = 8, 1, 448
    Hq, Hkv, Sk, Dh = 16, 8, 4096, 256
    assert Hq % Hkv == 0, (Hq, Hkv)
    return {
        "x": _w((lambda *s: torch.randn(*s, dtype=torch.bfloat16) * 0.8)(B, Sq, D)),
        "k_cache": _w((lambda *s: torch.randn(*s, dtype=torch.bfloat16) * 0.8)(B, Hkv, Sk, Dh)),
        "v_cache": _w((lambda *s: torch.randn(*s, dtype=torch.bfloat16) * 0.05)(B, Hkv, Sk, Dh)),
        "wq": _w((lambda *s: torch.randn(*s, dtype=torch.bfloat16) * 0.8)(D, Hq * Dh) * (D ** -0.5)),
        "wo": _w((lambda *s: torch.randn(*s, dtype=torch.bfloat16) * 0.05)(Hq * Dh, D) * ((Hq * Dh) ** -0.5)),
    }

def reference(x, k_cache, v_cache, wq, wo):
    B, Sq, D = x.shape
    Hq, Dh = 16, 256
    Hkv = k_cache.shape[1]
    rep = Hq // Hkv
    q = (lambda x, *d: x.permute(*d))((x @ wq).reshape(B, Sq, Hq, Dh), 0, 2, 1, 3)
    k = (lambda x, n, axis: torch.repeat_interleave(x, n, dim=axis))(k_cache, rep, axis=1)
    v = (lambda x, n, axis: torch.repeat_interleave(x, n, dim=axis))(v_cache, rep, axis=1)
    scores = torch.einsum("bhqd,bhkd->bhqk", q, k) * (Dh ** -0.5)
    p = _softmax(scores, axis=-1)
    o = torch.einsum("bhqk,bhkd->bhqd", p, v)
    return (lambda x, *d: x.permute(*d))(o, 0, 2, 1, 3).reshape(B, Sq, Hq * Dh) @ wo
```

```asm
; @launch grid=(256,1,1) block=(512,1,1) lds=149184
.amdgcn_target "amdgcn-amd-amdhsa--gfx950"
.text
.globl standalone__gqa_block_cached__decode_kernel
.p2align 8
.type standalone__gqa_block_cached__decode_kernel,@function
standalone__gqa_block_cached__decode_kernel:
s_cmp_ge_u32 s2, 256
s_cbranch_scc1 L_end
s_load_dwordx16 s[16:31], s[0:1], 0
v_lshrrev_b32 v1, 6, v0
s_and_b32 s56, s2, 7
v_readfirstlane_b32 s3, v1
s_lshr_b32 s4, s2, 3
s_mov_b32 s5, s56
s_and_b32 s6, s4, 7
s_lshr_b32 s7, s4, 3
s_lshl_b32 s8, s6, 3
s_add_u32 s8, s8, s5
v_and_b32 v1, 63, v0
s_cmp_ge_u32 s3, 4
s_cbranch_scc1 L_helper
s_lshl_b32 s10, s3, 15
s_lshl_b32 s11, s3, 12
v_lshrrev_b32 v64, 5, v1
v_and_b32 v65, 31, v1
v_xor_b32 v65, v65, v64
v_lshlrev_b32 v65, 4, v65
v_lshl_add_u32 v2, v64, 9, v65
v_xor_b32 v3, 32, v2
v_xor_b32 v4, 64, v2
v_xor_b32 v5, 96, v2
v_xor_b32 v6, 128, v2
v_xor_b32 v7, 160, v2
v_xor_b32 v8, 192, v2
v_xor_b32 v9, 224, v2
s_waitcnt lgkmcnt(0)
s_lshl_b32 s12, s8, 21
s_lshl_b32 s59, s7, 19
s_add_u32 s13, s12, s59
s_add_u32 s32, s18, s13
s_addc_u32 s33, s19, 0
s_mov_b32 s34, 0x80000
s_mov_b32 s35, 0x20000
s_add_u32 s36, s20, s12
s_addc_u32 s37, s21, 0
s_mov_b32 s38, 0x200000
s_mov_b32 s39, 0x20000
s_lshr_b32 s55, s4, 2
s_cmp_eq_u32 s55, 3
s_cselect_b32 s55, 2, 1
s_add_u32 m0, s10, 0
s_add_u32 s14, s11, 0
buffer_load_dwordx4 v2, s[32:35], s14 offen offset:0 nt lds
buffer_load_dwordx4 v3, s[32:35], s14 offen offset:1024 nt lds
buffer_load_dwordx4 v4, s[32:35], s14 offen offset:2048 nt lds
buffer_load_dwordx4 v5, s[32:35], s14 offen offset:3072 nt lds
s_add_u32 m0, s10, 4096
s_add_u32 s14, s11, 16384
buffer_load_dwordx4 v6, s[32:35], s14 offen offset:0 nt lds
buffer_load_dwordx4 v7, s[32:35], s14 offen offset:1024 nt lds
buffer_load_dwordx4 v8, s[32:35], s14 offen offset:2048 nt lds
buffer_load_dwordx4 v9, s[32:35], s14 offen offset:3072 nt lds
s_add_u32 m0, s10, 8192
s_add_u32 s14, s11, 32768
buffer_load_dwordx4 v2, s[32:35], s14 offen offset:0 nt lds
buffer_load_dwordx4 v3, s[32:35], s14 offen offset:1024 nt lds
v_lshrrev_b32 v64, 3, v1
v_lshrrev_b32 v65, 1, v64
v_and_b32 v65, 3, v65
v_lshlrev_b32 v65, 1, v65
v_and_b32 v66, 7, v1
v_xor_b32 v66, v66, v65
v_lshlrev_b32 v66, 4, v66
v_lshl_add_u32 v66, v64, 9, v66
s_lshl_b32 s15, s3, 7
v_add_u32 v18, s15, v66
v_add_u32 v19, 3072, v18
v_add_u32 v20, 6144, v18
v_add_u32 v21, 9216, v18
v_and_b32 v64, 15, v1
v_lshrrev_b32 v65, 4, v1
v_xor_b32 v66, v64, v65
v_lshlrev_b32 v66, 4, v66
v_lshl_add_u32 v66, v64, 9, v66
v_add_u32 v10, s10, v66
v_xor_b32 v11, 64, v10
v_xor_b32 v12, 128, v10
v_xor_b32 v13, 192, v10
v_xor_b32 v14, 256, v10
v_xor_b32 v15, 320, v10
v_xor_b32 v16, 384, v10
v_xor_b32 v17, 448, v10
v_and_b32 v66, 1, v65
v_lshrrev_b32 v67, 3, v64
v_lshl_or_b32 v67, v66, 1, v67
v_lshrrev_b32 v68, 2, v64
v_lshl_add_u32 v68, v66, 2, v68
v_lshlrev_b32 v68, 7, v68
v_lshrrev_b32 v69, 1, v65
v_lshl_add_u32 v68, v69, 11, v68
v_and_b32 v70, 3, v64
v_lshl_add_u32 v68, v70, 3, v68
v_add_u32 v68, s10, v68
v_xor_b32 v71, 0, v67
v_lshl_add_u32 v22, v71, 5, v68
v_xor_b32 v71, 1, v67
v_lshl_add_u32 v23, v71, 5, v68
v_xor_b32 v71, 2, v67
v_lshl_add_u32 v24, v71, 5, v68
v_xor_b32 v71, 3, v67
v_lshl_add_u32 v25, v71, 5, v68
v_and_b32 v66, 1, v64
v_mul_u32_u24 v72, 2112, v66
v_lshl_add_u32 v26, v65, 4, v72
v_add_u32 v26, 131072, v26
s_lshr_b32 s15, s3, 1
s_lshl_b32 s15, s15, 5
s_and_b32 s40, s3, 1
s_lshl_b32 s40, s40, 3
s_add_u32 s15, s15, s40
s_add_u32 s15, s15, 131072
v_lshl_add_u32 v27, v69, 6, v72
v_and_b32 v73, 1, v65
v_lshl_add_u32 v27, v73, 4, v27
v_add_u32 v27, s15, v27
v_lshlrev_b32 v28, 9, v66
v_lshl_add_u32 v28, v65, 4, v28
v_add_u32 v28, 147456, v28
v_lshlrev_b32 v29, 6, v66
v_add_u32 v29, 148480, v29
s_lshl_b32 s15, s3, 4
v_lshl_add_u32 v30, v65, 2, v29
v_add_u32 v30, s15, v30
s_waitcnt vmcnt(5)
buffer_load_dwordx4 v4, s[32:35], s14 offen offset:2048 nt lds
s_waitcnt vmcnt(5)
buffer_load_dwordx4 v5, s[32:35], s14 offen offset:3072 nt lds
s_waitcnt vmcnt(5)
s_add_u32 m0, s10, 12288
s_add_u32 s14, s11, 49152
buffer_load_dwordx4 v6, s[32:35], s14 offen offset:0 nt lds
s_waitcnt vmcnt(5)
buffer_load_dwordx4 v7, s[32:35], s14 offen offset:1024 nt lds
s_waitcnt vmcnt(5)
buffer_load_dwordx4 v8, s[32:35], s14 offen offset:2048 nt lds
s_waitcnt vmcnt(5)
buffer_load_dwordx4 v9, s[32:35], s14 offen offset:3072 nt lds
s_waitcnt vmcnt(5)
s_add_u32 m0, s10, 16384
s_add_u32 s14, s11, 65536
buffer_load_dwordx4 v2, s[32:35], s14 offen offset:0 nt lds
s_waitcnt vmcnt(5)
buffer_load_dwordx4 v3, s[32:35], s14 offen offset:1024 nt lds
s_waitcnt vmcnt(5)
buffer_load_dwordx4 v4, s[32:35], s14 offen offset:2048 nt lds
s_waitcnt vmcnt(5)
buffer_load_dwordx4 v5, s[32:35], s14 offen offset:3072 nt lds
s_waitcnt vmcnt(5)
s_add_u32 m0, s10, 20480
s_add_u32 s14, s11, 81920
buffer_load_dwordx4 v6, s[32:35], s14 offen offset:0 nt lds
s_waitcnt vmcnt(5)
buffer_load_dwordx4 v7, s[32:35], s14 offen offset:1024 nt lds
s_waitcnt vmcnt(5)
buffer_load_dwordx4 v8, s[32:35], s14 offen offset:2048 nt lds
s_waitcnt vmcnt(5)
buffer_load_dwordx4 v9, s[32:35], s14 offen offset:3072 nt lds
s_waitcnt vmcnt(5)
s_add_u32 m0, s10, 24576
s_add_u32 s14, s11, 98304
buffer_load_dwordx4 v2, s[32:35], s14 offen offset:0 nt lds
s_waitcnt vmcnt(5)
buffer_load_dwordx4 v3, s[32:35], s14 offen offset:1024 nt lds
s_waitcnt vmcnt(5)
buffer_load_dwordx4 v4, s[32:35], s14 offen offset:2048 nt lds
s_waitcnt vmcnt(5)
buffer_load_dwordx4 v5, s[32:35], s14 offen offset:3072 nt lds
s_waitcnt vmcnt(5)
s_add_u32 m0, s10, 28672
s_add_u32 s14, s11, 114688
buffer_load_dwordx4 v6, s[32:35], s14 offen offset:0 nt lds
s_waitcnt vmcnt(5)
buffer_load_dwordx4 v7, s[32:35], s14 offen offset:1024 nt lds
s_waitcnt vmcnt(5)
buffer_load_dwordx4 v8, s[32:35], s14 offen offset:2048 nt lds
s_waitcnt vmcnt(5)
buffer_load_dwordx4 v9, s[32:35], s14 offen offset:3072 nt lds
ds_read_b128 v[128:131], v10 offset:0
ds_read_b128 v[132:135], v11 offset:0
ds_read_b128 v[136:139], v12 offset:0
ds_read_b128 v[140:143], v13 offset:0
ds_read_b128 v[144:147], v14 offset:0
ds_read_b128 v[148:151], v15 offset:0
ds_read_b128 v[152:155], v16 offset:0
ds_read_b128 v[156:159], v17 offset:0
s_waitcnt lgkmcnt(0)
s_waitcnt vmcnt(5)
s_add_u32 m0, s10, 0
s_add_u32 s14, s11, 131072
buffer_load_dwordx4 v2, s[32:35], s14 offen offset:0 nt lds
s_waitcnt vmcnt(5)
buffer_load_dwordx4 v3, s[32:35], s14 offen offset:1024 nt lds
s_waitcnt vmcnt(5)
buffer_load_dwordx4 v4, s[32:35], s14 offen offset:2048 nt lds
s_waitcnt vmcnt(5)
buffer_load_dwordx4 v5, s[32:35], s14 offen offset:3072 nt lds
s_waitcnt vmcnt(5)
s_add_u32 m0, s10, 4096
s_add_u32 s14, s11, 147456
buffer_load_dwordx4 v6, s[32:35], s14 offen offset:0 nt lds
s_waitcnt vmcnt(5)
buffer_load_dwordx4 v7, s[32:35], s14 offen offset:1024 nt lds
s_waitcnt vmcnt(5)
buffer_load_dwordx4 v8, s[32:35], s14 offen offset:2048 nt lds
s_waitcnt vmcnt(5)
buffer_load_dwordx4 v9, s[32:35], s14 offen offset:3072 nt lds
ds_read_b128 v[160:163], v10 offset:8192
ds_read_b128 v[164:167], v11 offset:8192
ds_read_b128 v[168:171], v12 offset:8192
ds_read_b128 v[172:175], v13 offset:8192
ds_read_b128 v[176:179], v14 offset:8192
ds_read_b128 v[180:183], v15 offset:8192
ds_read_b128 v[184:187], v16 offset:8192
ds_read_b128 v[188:191], v17 offset:8192
s_waitcnt lgkmcnt(0)
s_waitcnt vmcnt(5)
s_add_u32 m0, s10, 8192
s_add_u32 s14, s11, 163840
buffer_load_dwordx4 v2, s[32:35], s14 offen offset:0 nt lds
s_waitcnt vmcnt(5)
buffer_load_dwordx4 v3, s[32:35], s14 offen offset:1024 nt lds
s_waitcnt vmcnt(5)
buffer_load_dwordx4 v4, s[32:35], s14 offen offset:2048 nt lds
s_waitcnt vmcnt(5)
buffer_load_dwordx4 v5, s[32:35], s14 offen offset:3072 nt lds
s_waitcnt vmcnt(5)
s_add_u32 m0, s10, 12288
s_add_u32 s14, s11, 180224
buffer_load_dwordx4 v6, s[32:35], s14 offen offset:0 nt lds
s_waitcnt vmcnt(5)
buffer_load_dwordx4 v7, s[32:35], s14 offen offset:1024 nt lds
s_waitcnt vmcnt(5)
buffer_load_dwordx4 v8, s[32:35], s14 offen offset:2048 nt lds
s_waitcnt vmcnt(5)
buffer_load_dwordx4 v9, s[32:35], s14 offen offset:3072 nt lds
s_barrier
ds_read_b128 v[192:195], v10 offset:16384
ds_read_b128 v[196:199], v11 offset:16384
ds_read_b128 v[200:203], v12 offset:16384
ds_read_b128 v[204:207], v13 offset:16384
ds_read_b128 v[208:211], v14 offset:16384
ds_read_b128 v[212:215], v15 offset:16384
ds_read_b128 v[216:219], v16 offset:16384
ds_read_b128 v[220:223], v17 offset:16384
s_waitcnt lgkmcnt(0)
s_waitcnt vmcnt(5)
s_add_u32 m0, s10, 16384
s_add_u32 s14, s11, 196608
buffer_load_dwordx4 v2, s[32:35], s14 offen offset:0 nt lds
s_waitcnt vmcnt(5)
buffer_load_dwordx4 v3, s[32:35], s14 offen offset:1024 nt lds
s_waitcnt vmcnt(5)
buffer_load_dwordx4 v4, s[32:35], s14 offen offset:2048 nt lds
s_waitcnt vmcnt(5)
buffer_load_dwordx4 v5, s[32:35], s14 offen offset:3072 nt lds
s_waitcnt vmcnt(5)
s_add_u32 m0, s10, 20480
s_add_u32 s14, s11, 212992
buffer_load_dwordx4 v6, s[32:35], s14 offen offset:0 nt lds
s_waitcnt vmcnt(5)
buffer_load_dwordx4 v7, s[32:35], s14 offen offset:1024 nt lds
s_waitcnt vmcnt(5)
buffer_load_dwordx4 v8, s[32:35], s14 offen offset:2048 nt lds
s_waitcnt vmcnt(5)
buffer_load_dwordx4 v9, s[32:35], s14 offen offset:3072 nt lds
ds_read_b128 v[224:227], v10 offset:24576
ds_read_b128 v[228:231], v11 offset:24576
ds_read_b128 v[232:235], v12 offset:24576
ds_read_b128 v[236:239], v13 offset:24576
ds_read_b128 v[240:243], v14 offset:24576
ds_read_b128 v[244:247], v15 offset:24576
ds_read_b128 v[248:251], v16 offset:24576
ds_read_b128 v[252:255], v17 offset:24576
s_waitcnt lgkmcnt(0)
s_waitcnt vmcnt(5)
s_add_u32 m0, s10, 24576
s_add_u32 s14, s11, 229376
buffer_load_dwordx4 v2, s[32:35], s14 offen offset:0 nt lds
s_waitcnt vmcnt(5)
buffer_load_dwordx4 v3, s[32:35], s14 offen offset:1024 nt lds
s_waitcnt vmcnt(5)
buffer_load_dwordx4 v4, s[32:35], s14 offen offset:2048 nt lds
s_waitcnt vmcnt(5)
buffer_load_dwordx4 v5, s[32:35], s14 offen offset:3072 nt lds
s_waitcnt vmcnt(5)
s_add_u32 m0, s10, 28672
s_add_u32 s14, s11, 245760
buffer_load_dwordx4 v6, s[32:35], s14 offen offset:0 nt lds
s_waitcnt vmcnt(5)
buffer_load_dwordx4 v7, s[32:35], s14 offen offset:1024 nt lds
s_waitcnt vmcnt(5)
buffer_load_dwordx4 v8, s[32:35], s14 offen offset:2048 nt lds
s_waitcnt vmcnt(5)
buffer_load_dwordx4 v9, s[32:35], s14 offen offset:3072 nt lds
s_barrier
ds_read_b128 v[32:35], v28 offset:0
ds_read_b128 v[36:39], v28 offset:64
ds_read_b128 v[40:43], v28 offset:128
ds_read_b128 v[44:47], v28 offset:192
ds_read_b128 v[48:51], v28 offset:256
ds_read_b128 v[52:55], v28 offset:320
ds_read_b128 v[56:59], v28 offset:384
ds_read_b128 v[60:63], v28 offset:448
v_mov_b32 v31, 148736
ds_read_b32 v31, v31
s_waitcnt lgkmcnt(0)
v_readfirstlane_b32 s9, v31
v_mfma_f32_16x16x32_bf16 v[64:67], v[128:131], v[32:35], 0
v_mfma_f32_16x16x32_bf16 v[64:67], v[132:135], v[36:39], v[64:67]
v_mfma_f32_16x16x32_bf16 v[64:67], v[136:139], v[40:43], v[64:67]
v_mfma_f32_16x16x32_bf16 v[64:67], v[140:143], v[44:47], v[64:67]
v_mfma_f32_16x16x32_bf16 v[64:67], v[144:147], v[48:51], v[64:67]
v_mfma_f32_16x16x32_bf16 v[64:67], v[148:151], v[52:55], v[64:67]
v_mfma_f32_16x16x32_bf16 v[64:67], v[152:155], v[56:59], v[64:67]
v_mfma_f32_16x16x32_bf16 v[64:67], v[156:159], v[60:63], v[64:67]
ds_read_b128 v[128:131], v10 offset:0
ds_read_b128 v[132:135], v11 offset:0
ds_read_b128 v[136:139], v12 offset:0
ds_read_b128 v[140:143], v13 offset:0
ds_read_b128 v[144:147], v14 offset:0
ds_read_b128 v[148:151], v15 offset:0
ds_read_b128 v[152:155], v16 offset:0
ds_read_b128 v[156:159], v17 offset:0
s_waitcnt lgkmcnt(7)
v_mfma_f32_16x16x32_bf16 v[80:83], v[128:131], v[32:35], 0
s_waitcnt lgkmcnt(6)
v_mfma_f32_16x16x32_bf16 v[80:83], v[132:135], v[36:39], v[80:83]
s_waitcnt lgkmcnt(5)
v_mfma_f32_16x16x32_bf16 v[80:83], v[136:139], v[40:43], v[80:83]
s_waitcnt lgkmcnt(4)
v_mfma_f32_16x16x32_bf16 v[80:83], v[140:143], v[44:47], v[80:83]
s_waitcnt lgkmcnt(3)
v_mfma_f32_16x16x32_bf16 v[80:83], v[144:147], v[48:51], v[80:83]
s_waitcnt lgkmcnt(2)
v_mfma_f32_16x16x32_bf16 v[80:83], v[148:151], v[52:55], v[80:83]
s_waitcnt lgkmcnt(1)
v_mfma_f32_16x16x32_bf16 v[80:83], v[152:155], v[56:59], v[80:83]
s_waitcnt lgkmcnt(0)
v_mfma_f32_16x16x32_bf16 v[80:83], v[156:159], v[60:63], v[80:83]
s_cmp_eq_u32 s55, 2
s_cbranch_scc1 L_lv1b
s_waitcnt vmcnt(5)
L_lv1b:
s_add_u32 m0, s10, 0
s_add_u32 s14, s11, 262144
buffer_load_dwordx4 v2, s[32:35], s14 offen offset:0 nt lds
s_cmp_eq_u32 s55, 2
s_cbranch_scc1 L_lv2b
s_waitcnt vmcnt(5)
L_lv2b:
s_waitcnt vmcnt(6)
buffer_load_dwordx4 v3, s[32:35], s14 offen offset:1024 nt lds
s_cmp_eq_u32 s55, 2
s_cbranch_scc1 L_lv3b
s_waitcnt vmcnt(5)
L_lv3b:
s_waitcnt vmcnt(6)
buffer_load_dwordx4 v4, s[32:35], s14 offen offset:2048 nt lds
s_cmp_eq_u32 s55, 2
s_cbranch_scc1 L_lv4b
s_waitcnt vmcnt(5)
L_lv4b:
s_waitcnt vmcnt(6)
buffer_load_dwordx4 v5, s[32:35], s14 offen offset:3072 nt lds
s_cmp_eq_u32 s55, 2
s_cbranch_scc1 L_lv5b
s_waitcnt vmcnt(5)
L_lv5b:
s_waitcnt vmcnt(6)
s_add_u32 m0, s10, 4096
s_add_u32 s14, s11, 278528
buffer_load_dwordx4 v6, s[32:35], s14 offen offset:0 nt lds
s_cmp_eq_u32 s55, 2
s_cbranch_scc1 L_lv6b
s_waitcnt vmcnt(5)
L_lv6b:
s_waitcnt vmcnt(6)
buffer_load_dwordx4 v7, s[32:35], s14 offen offset:1024 nt lds
v_cvt_pk_bf16_f32 v31, v64, v65
v_lshlrev_b32 v64, 16, v31
v_and_b32 v65, 0xffff0000, v31
v_cvt_pk_bf16_f32 v31, v66, v67
v_lshlrev_b32 v66, 16, v31
v_and_b32 v67, 0xffff0000, v31
s_cmp_eq_u32 s55, 2
s_cbranch_scc1 L_lv7b
s_waitcnt vmcnt(5)
L_lv7b:
s_waitcnt vmcnt(6)
buffer_load_dwordx4 v8, s[32:35], s14 offen offset:2048 nt lds
s_cmp_eq_u32 s55, 2
s_cbranch_scc1 L_lv8b
s_waitcnt vmcnt(5)
L_lv8b:
s_waitcnt vmcnt(6)
buffer_load_dwordx4 v9, s[32:35], s14 offen offset:3072 nt lds
ds_read_b128 v[128:131], v10 offset:8192
ds_read_b128 v[132:135], v11 offset:8192
ds_read_b128 v[136:139], v12 offset:8192
ds_read_b128 v[140:143], v13 offset:8192
ds_read_b128 v[144:147], v14 offset:8192
ds_read_b128 v[148:151], v15 offset:8192
ds_read_b128 v[152:155], v16 offset:8192
ds_read_b128 v[156:159], v17 offset:8192
s_waitcnt lgkmcnt(7)
v_mfma_f32_16x16x32_bf16 v[84:87], v[128:131], v[32:35], 0
s_waitcnt lgkmcnt(6)
v_mfma_f32_16x16x32_bf16 v[84:87], v[132:135], v[36:39], v[84:87]
s_waitcnt lgkmcnt(5)
v_mfma_f32_16x16x32_bf16 v[84:87], v[136:139], v[40:43], v[84:87]
s_waitcnt lgkmcnt(4)
v_mfma_f32_16x16x32_bf16 v[84:87], v[140:143], v[44:47], v[84:87]
s_waitcnt lgkmcnt(3)
v_mfma_f32_16x16x32_bf16 v[84:87], v[144:147], v[48:51], v[84:87]
s_waitcnt lgkmcnt(2)
v_mfma_f32_16x16x32_bf16 v[84:87], v[148:151], v[52:55], v[84:87]
s_waitcnt lgkmcnt(1)
v_mfma_f32_16x16x32_bf16 v[84:87], v[152:155], v[56:59], v[84:87]
s_waitcnt lgkmcnt(0)
v_mfma_f32_16x16x32_bf16 v[84:87], v[156:159], v[60:63], v[84:87]
v_cvt_pk_bf16_f32 v31, v80, v81
v_lshlrev_b32 v80, 16, v31
v_and_b32 v81, 0xffff0000, v31
v_cvt_pk_bf16_f32 v31, v82, v83
v_lshlrev_b32 v82, 16, v31
v_and_b32 v83, 0xffff0000, v31
s_cmp_eq_u32 s55, 2
s_cbranch_scc1 L_lv9b
s_waitcnt vmcnt(5)
L_lv9b:
s_waitcnt vmcnt(6)
s_add_u32 m0, s10, 8192
s_add_u32 s14, s11, 294912
buffer_load_dwordx4 v2, s[32:35], s14 offen offset:0 nt lds
s_cmp_eq_u32 s55, 2
s_cbranch_scc1 L_lv10b
s_waitcnt vmcnt(5)
L_lv10b:
s_waitcnt vmcnt(6)
buffer_load_dwordx4 v3, s[32:35], s14 offen offset:1024 nt lds
ds_read_b128 v[128:131], v10 offset:16384
ds_read_b128 v[132:135], v11 offset:16384
ds_read_b128 v[136:139], v12 offset:16384
ds_read_b128 v[140:143], v13 offset:16384
ds_read_b128 v[144:147], v14 offset:16384
ds_read_b128 v[148:151], v15 offset:16384
ds_read_b128 v[152:155], v16 offset:16384
ds_read_b128 v[156:159], v17 offset:16384
s_waitcnt lgkmcnt(7)
v_mfma_f32_16x16x32_bf16 v[88:91], v[128:131], v[32:35], 0
s_waitcnt lgkmcnt(6)
v_mfma_f32_16x16x32_bf16 v[88:91], v[132:135], v[36:39], v[88:91]
s_waitcnt lgkmcnt(5)
v_mfma_f32_16x16x32_bf16 v[88:91], v[136:139], v[40:43], v[88:91]
s_waitcnt lgkmcnt(4)
v_mfma_f32_16x16x32_bf16 v[88:91], v[140:143], v[44:47], v[88:91]
s_waitcnt lgkmcnt(3)
v_mfma_f32_16x16x32_bf16 v[88:91], v[144:147], v[48:51], v[88:91]
s_waitcnt lgkmcnt(2)
v_mfma_f32_16x16x32_bf16 v[88:91], v[148:151], v[52:55], v[88:91]
s_waitcnt lgkmcnt(1)
v_mfma_f32_16x16x32_bf16 v[88:91], v[152:155], v[56:59], v[88:91]
s_waitcnt lgkmcnt(0)
v_mfma_f32_16x16x32_bf16 v[88:91], v[156:159], v[60:63], v[88:91]
v_cvt_pk_bf16_f32 v31, v84, v85
v_lshlrev_b32 v84, 16, v31
v_and_b32 v85, 0xffff0000, v31
v_cvt_pk_bf16_f32 v31, v86, v87
v_lshlrev_b32 v86, 16, v31
v_and_b32 v87, 0xffff0000, v31
s_cmp_eq_u32 s55, 2
s_cbranch_scc1 L_lv11b
s_waitcnt vmcnt(5)
L_lv11b:
s_waitcnt vmcnt(6)
buffer_load_dwordx4 v4, s[32:35], s14 offen offset:2048 nt lds
s_cmp_eq_u32 s55, 2
s_cbranch_scc1 L_lv12b
s_waitcnt vmcnt(5)
L_lv12b:
s_waitcnt vmcnt(6)
buffer_load_dwordx4 v5, s[32:35], s14 offen offset:3072 nt lds
ds_read_b128 v[128:131], v10 offset:24576
ds_read_b128 v[132:135], v11 offset:24576
ds_read_b128 v[136:139], v12 offset:24576
ds_read_b128 v[140:143], v13 offset:24576
ds_read_b128 v[144:147], v14 offset:24576
ds_read_b128 v[148:151], v15 offset:24576
ds_read_b128 v[152:155], v16 offset:24576
ds_read_b128 v[156:159], v17 offset:24576
s_waitcnt lgkmcnt(7)
v_mfma_f32_16x16x32_bf16 v[92:95], v[128:131], v[32:35], 0
s_waitcnt lgkmcnt(6)
v_mfma_f32_16x16x32_bf16 v[92:95], v[132:135], v[36:39], v[92:95]
s_waitcnt lgkmcnt(5)
v_mfma_f32_16x16x32_bf16 v[92:95], v[136:139], v[40:43], v[92:95]
s_waitcnt lgkmcnt(4)
v_mfma_f32_16x16x32_bf16 v[92:95], v[140:143], v[44:47], v[92:95]
s_waitcnt lgkmcnt(3)
v_mfma_f32_16x16x32_bf16 v[92:95], v[144:147], v[48:51], v[92:95]
s_waitcnt lgkmcnt(2)
v_mfma_f32_16x16x32_bf16 v[92:95], v[148:151], v[52:55], v[92:95]
s_waitcnt lgkmcnt(1)
v_mfma_f32_16x16x32_bf16 v[92:95], v[152:155], v[56:59], v[92:95]
s_waitcnt lgkmcnt(0)
v_mfma_f32_16x16x32_bf16 v[92:95], v[156:159], v[60:63], v[92:95]
v_cvt_pk_bf16_f32 v31, v88, v89
v_lshlrev_b32 v88, 16, v31
v_and_b32 v89, 0xffff0000, v31
v_cvt_pk_bf16_f32 v31, v90, v91
v_lshlrev_b32 v90, 16, v31
v_and_b32 v91, 0xffff0000, v31
s_cmp_eq_u32 s55, 2
s_cbranch_scc1 L_lv13b
s_waitcnt vmcnt(5)
L_lv13b:
s_waitcnt vmcnt(6)
s_add_u32 m0, s10, 12288
s_add_u32 s14, s11, 311296
buffer_load_dwordx4 v6, s[32:35], s14 offen offset:0 nt lds
s_cmp_eq_u32 s55, 2
s_cbranch_scc1 L_lv14b
s_waitcnt vmcnt(5)
L_lv14b:
s_waitcnt vmcnt(6)
buffer_load_dwordx4 v7, s[32:35], s14 offen offset:1024 nt lds
v_mfma_f32_16x16x32_bf16 v[68:71], v[160:163], v[32:35], 0
v_mfma_f32_16x16x32_bf16 v[68:71], v[164:167], v[36:39], v[68:71]
v_mfma_f32_16x16x32_bf16 v[68:71], v[168:171], v[40:43], v[68:71]
v_mfma_f32_16x16x32_bf16 v[68:71], v[172:175], v[44:47], v[68:71]
v_mfma_f32_16x16x32_bf16 v[68:71], v[176:179], v[48:51], v[68:71]
v_mfma_f32_16x16x32_bf16 v[68:71], v[180:183], v[52:55], v[68:71]
v_mfma_f32_16x16x32_bf16 v[68:71], v[184:187], v[56:59], v[68:71]
v_mfma_f32_16x16x32_bf16 v[68:71], v[188:191], v[60:63], v[68:71]
v_cvt_pk_bf16_f32 v31, v92, v93
v_lshlrev_b32 v92, 16, v31
v_and_b32 v93, 0xffff0000, v31
v_cvt_pk_bf16_f32 v31, v94, v95
v_lshlrev_b32 v94, 16, v31
v_and_b32 v95, 0xffff0000, v31
s_cmp_eq_u32 s55, 2
s_cbranch_scc1 L_lv15b
s_waitcnt vmcnt(5)
L_lv15b:
s_waitcnt vmcnt(6)
buffer_load_dwordx4 v8, s[32:35], s14 offen offset:2048 nt lds
s_cmp_eq_u32 s55, 2
s_cbranch_scc1 L_lv16b
s_waitcnt vmcnt(5)
L_lv16b:
s_waitcnt vmcnt(6)
buffer_load_dwordx4 v9, s[32:35], s14 offen offset:3072 nt lds
v_mfma_f32_16x16x32_bf16 v[72:75], v[192:195], v[32:35], 0
v_mfma_f32_16x16x32_bf16 v[72:75], v[196:199], v[36:39], v[72:75]
v_mfma_f32_16x16x32_bf16 v[72:75], v[200:203], v[40:43], v[72:75]
v_mfma_f32_16x16x32_bf16 v[72:75], v[204:207], v[44:47], v[72:75]
v_mfma_f32_16x16x32_bf16 v[72:75], v[208:211], v[48:51], v[72:75]
v_mfma_f32_16x16x32_bf16 v[72:75], v[212:215], v[52:55], v[72:75]
v_mfma_f32_16x16x32_bf16 v[72:75], v[216:219], v[56:59], v[72:75]
v_mfma_f32_16x16x32_bf16 v[72:75], v[220:223], v[60:63], v[72:75]
v_cvt_pk_bf16_f32 v31, v68, v69
v_lshlrev_b32 v68, 16, v31
v_and_b32 v69, 0xffff0000, v31
v_cvt_pk_bf16_f32 v31, v70, v71
v_lshlrev_b32 v70, 16, v31
v_and_b32 v71, 0xffff0000, v31
s_cmp_eq_u32 s55, 2
s_cbranch_scc1 L_lv17b
s_waitcnt vmcnt(5)
L_lv17b:
s_waitcnt vmcnt(6)
s_add_u32 m0, s10, 16384
s_add_u32 s14, s11, 327680
buffer_load_dwordx4 v2, s[32:35], s14 offen offset:0 nt lds
s_cmp_eq_u32 s55, 2
s_cbranch_scc1 L_lv18b
s_waitcnt vmcnt(5)
L_lv18b:
s_waitcnt vmcnt(6)
buffer_load_dwordx4 v3, s[32:35], s14 offen offset:1024 nt lds
v_mfma_f32_16x16x32_bf16 v[76:79], v[224:227], v[32:35], 0
v_mfma_f32_16x16x32_bf16 v[76:79], v[228:231], v[36:39], v[76:79]
v_mfma_f32_16x16x32_bf16 v[76:79], v[232:235], v[40:43], v[76:79]
v_mfma_f32_16x16x32_bf16 v[76:79], v[236:239], v[44:47], v[76:79]
v_mfma_f32_16x16x32_bf16 v[76:79], v[240:243], v[48:51], v[76:79]
v_mfma_f32_16x16x32_bf16 v[76:79], v[244:247], v[52:55], v[76:79]
v_mfma_f32_16x16x32_bf16 v[76:79], v[248:251], v[56:59], v[76:79]
v_mfma_f32_16x16x32_bf16 v[76:79], v[252:255], v[60:63], v[76:79]
v_cvt_pk_bf16_f32 v31, v72, v73
v_lshlrev_b32 v72, 16, v31
v_and_b32 v73, 0xffff0000, v31
v_cvt_pk_bf16_f32 v31, v74, v75
v_lshlrev_b32 v74, 16, v31
v_and_b32 v75, 0xffff0000, v31
ds_read_b128 v[128:131], v10 offset:0
ds_read_b128 v[132:135], v11 offset:0
ds_read_b128 v[136:139], v12 offset:0
ds_read_b128 v[140:143], v13 offset:0
ds_read_b128 v[144:147], v14 offset:0
ds_read_b128 v[148:151], v15 offset:0
ds_read_b128 v[152:155], v16 offset:0
ds_read_b128 v[156:159], v17 offset:0
s_waitcnt lgkmcnt(7)
v_mfma_f32_16x16x32_bf16 v[96:99], v[128:131], v[32:35], 0
s_waitcnt lgkmcnt(6)
v_mfma_f32_16x16x32_bf16 v[96:99], v[132:135], v[36:39], v[96:99]
s_waitcnt lgkmcnt(5)
v_mfma_f32_16x16x32_bf16 v[96:99], v[136:139], v[40:43], v[96:99]
s_waitcnt lgkmcnt(4)
v_mfma_f32_16x16x32_bf16 v[96:99], v[140:143], v[44:47], v[96:99]
s_waitcnt lgkmcnt(3)
v_mfma_f32_16x16x32_bf16 v[96:99], v[144:147], v[48:51], v[96:99]
s_waitcnt lgkmcnt(2)
v_mfma_f32_16x16x32_bf16 v[96:99], v[148:151], v[52:55], v[96:99]
s_waitcnt lgkmcnt(1)
v_mfma_f32_16x16x32_bf16 v[96:99], v[152:155], v[56:59], v[96:99]
s_waitcnt lgkmcnt(0)
v_mfma_f32_16x16x32_bf16 v[96:99], v[156:159], v[60:63], v[96:99]
v_cvt_pk_bf16_f32 v31, v76, v77
v_lshlrev_b32 v76, 16, v31
v_and_b32 v77, 0xffff0000, v31
v_cvt_pk_bf16_f32 v31, v78, v79
v_lshlrev_b32 v78, 16, v31
v_and_b32 v79, 0xffff0000, v31
s_cmp_eq_u32 s55, 2
s_cbranch_scc1 L_lv19b
s_waitcnt vmcnt(5)
L_lv19b:
s_waitcnt vmcnt(6)
buffer_load_dwordx4 v4, s[32:35], s14 offen offset:2048 nt lds
s_cmp_eq_u32 s55, 2
s_cbranch_scc1 L_lv20b
s_waitcnt vmcnt(5)
L_lv20b:
s_waitcnt vmcnt(6)
buffer_load_dwordx4 v5, s[32:35], s14 offen offset:3072 nt lds
s_cmp_eq_u32 s55, 2
s_cbranch_scc1 L_lv21b
s_waitcnt vmcnt(5)
L_lv21b:
s_waitcnt vmcnt(6)
s_add_u32 m0, s10, 20480
s_add_u32 s14, s11, 344064
buffer_load_dwordx4 v6, s[32:35], s14 offen offset:0 nt lds
s_cmp_eq_u32 s55, 2
s_cbranch_scc1 L_lv22b
s_waitcnt vmcnt(5)
L_lv22b:
s_waitcnt vmcnt(6)
buffer_load_dwordx4 v7, s[32:35], s14 offen offset:1024 nt lds
s_cmp_eq_u32 s55, 2
s_cbranch_scc1 L_lv23b
s_waitcnt vmcnt(5)
L_lv23b:
s_waitcnt vmcnt(6)
buffer_load_dwordx4 v8, s[32:35], s14 offen offset:2048 nt lds
s_cmp_eq_u32 s55, 2
s_cbranch_scc1 L_lv24b
s_waitcnt vmcnt(5)
L_lv24b:
s_waitcnt vmcnt(6)
buffer_load_dwordx4 v9, s[32:35], s14 offen offset:3072 nt lds
ds_read_b128 v[128:131], v10 offset:8192
ds_read_b128 v[132:135], v11 offset:8192
ds_read_b128 v[136:139], v12 offset:8192
ds_read_b128 v[140:143], v13 offset:8192
ds_read_b128 v[144:147], v14 offset:8192
ds_read_b128 v[148:151], v15 offset:8192
ds_read_b128 v[152:155], v16 offset:8192
ds_read_b128 v[156:159], v17 offset:8192
s_waitcnt lgkmcnt(7)
v_mfma_f32_16x16x32_bf16 v[100:103], v[128:131], v[32:35], 0
s_waitcnt lgkmcnt(6)
v_mfma_f32_16x16x32_bf16 v[100:103], v[132:135], v[36:39], v[100:103]
s_waitcnt lgkmcnt(5)
v_mfma_f32_16x16x32_bf16 v[100:103], v[136:139], v[40:43], v[100:103]
s_waitcnt lgkmcnt(4)
v_mfma_f32_16x16x32_bf16 v[100:103], v[140:143], v[44:47], v[100:103]
s_waitcnt lgkmcnt(3)
v_mfma_f32_16x16x32_bf16 v[100:103], v[144:147], v[48:51], v[100:103]
s_waitcnt lgkmcnt(2)
v_mfma_f32_16x16x32_bf16 v[100:103], v[148:151], v[52:55], v[100:103]
s_waitcnt lgkmcnt(1)
v_mfma_f32_16x16x32_bf16 v[100:103], v[152:155], v[56:59], v[100:103]
s_waitcnt lgkmcnt(0)
v_mfma_f32_16x16x32_bf16 v[100:103], v[156:159], v[60:63], v[100:103]
v_cvt_pk_bf16_f32 v31, v96, v97
v_lshlrev_b32 v96, 16, v31
v_and_b32 v97, 0xffff0000, v31
v_cvt_pk_bf16_f32 v31, v98, v99
v_lshlrev_b32 v98, 16, v31
v_and_b32 v99, 0xffff0000, v31
s_cmp_eq_u32 s55, 2
s_cbranch_scc1 L_lv25b
s_waitcnt vmcnt(5)
L_lv25b:
s_waitcnt vmcnt(6)
s_add_u32 m0, s10, 24576
s_add_u32 s14, s11, 360448
buffer_load_dwordx4 v2, s[32:35], s14 offen offset:0 nt lds
s_cmp_eq_u32 s55, 2
s_cbranch_scc1 L_lv26b
s_waitcnt vmcnt(5)
L_lv26b:
s_waitcnt vmcnt(6)
buffer_load_dwordx4 v3, s[32:35], s14 offen offset:1024 nt lds
s_cmp_eq_u32 s55, 2
s_cbranch_scc1 L_lv27b
s_waitcnt vmcnt(5)
L_lv27b:
s_waitcnt vmcnt(6)
buffer_load_dwordx4 v4, s[32:35], s14 offen offset:2048 nt lds
s_cmp_eq_u32 s55, 2
s_cbranch_scc1 L_lv28b
s_waitcnt vmcnt(5)
L_lv28b:
s_waitcnt vmcnt(6)
buffer_load_dwordx4 v5, s[32:35], s14 offen offset:3072 nt lds
s_cmp_eq_u32 s55, 2
s_cbranch_scc1 L_lv29b
s_waitcnt vmcnt(5)
L_lv29b:
s_waitcnt vmcnt(6)
s_add_u32 m0, s10, 28672
s_add_u32 s14, s11, 376832
buffer_load_dwordx4 v6, s[32:35], s14 offen offset:0 nt lds
s_cmp_eq_u32 s55, 2
s_cbranch_scc1 L_lv30b
s_waitcnt vmcnt(5)
L_lv30b:
s_waitcnt vmcnt(6)
buffer_load_dwordx4 v7, s[32:35], s14 offen offset:1024 nt lds
s_cmp_eq_u32 s55, 2
s_cbranch_scc1 L_lv31b
s_waitcnt vmcnt(5)
L_lv31b:
s_waitcnt vmcnt(6)
buffer_load_dwordx4 v8, s[32:35], s14 offen offset:2048 nt lds
s_cmp_eq_u32 s55, 2
s_cbranch_scc1 L_lv32b
s_waitcnt vmcnt(5)
L_lv32b:
s_waitcnt vmcnt(6)
buffer_load_dwordx4 v9, s[32:35], s14 offen offset:3072 nt lds
ds_read_b128 v[128:131], v10 offset:16384
ds_read_b128 v[132:135], v11 offset:16384
ds_read_b128 v[136:139], v12 offset:16384
ds_read_b128 v[140:143], v13 offset:16384
ds_read_b128 v[144:147], v14 offset:16384
ds_read_b128 v[148:151], v15 offset:16384
ds_read_b128 v[152:155], v16 offset:16384
ds_read_b128 v[156:159], v17 offset:16384
s_waitcnt lgkmcnt(7)
v_mfma_f32_16x16x32_bf16 v[104:107], v[128:131], v[32:35], 0
s_waitcnt lgkmcnt(6)
v_mfma_f32_16x16x32_bf16 v[104:107], v[132:135], v[36:39], v[104:107]
s_waitcnt lgkmcnt(5)
v_mfma_f32_16x16x32_bf16 v[104:107], v[136:139], v[40:43], v[104:107]
s_waitcnt lgkmcnt(4)
v_mfma_f32_16x16x32_bf16 v[104:107], v[140:143], v[44:47], v[104:107]
s_waitcnt lgkmcnt(3)
v_mfma_f32_16x16x32_bf16 v[104:107], v[144:147], v[48:51], v[104:107]
s_waitcnt lgkmcnt(2)
v_mfma_f32_16x16x32_bf16 v[104:107], v[148:151], v[52:55], v[104:107]
s_waitcnt lgkmcnt(1)
v_mfma_f32_16x16x32_bf16 v[104:107], v[152:155], v[56:59], v[104:107]
s_waitcnt lgkmcnt(0)
v_mfma_f32_16x16x32_bf16 v[104:107], v[156:159], v[60:63], v[104:107]
v_cvt_pk_bf16_f32 v31, v100, v101
v_lshlrev_b32 v100, 16, v31
v_and_b32 v101, 0xffff0000, v31
v_cvt_pk_bf16_f32 v31, v102, v103
v_lshlrev_b32 v102, 16, v31
v_and_b32 v103, 0xffff0000, v31
s_cmp_eq_u32 s55, 2
s_cbranch_scc1 L_lv33b
s_waitcnt vmcnt(5)
L_lv33b:
s_waitcnt vmcnt(6)
s_add_u32 m0, s10, 0
s_add_u32 s14, s11, 393216
buffer_load_dwordx4 v2, s[32:35], s14 offen offset:0 nt lds
s_cmp_eq_u32 s55, 2
s_cbranch_scc1 L_lv34b
s_waitcnt vmcnt(5)
L_lv34b:
s_waitcnt vmcnt(6)
buffer_load_dwordx4 v3, s[32:35], s14 offen offset:1024 nt lds
s_cmp_eq_u32 s55, 2
s_cbranch_scc1 L_lv35b
s_waitcnt vmcnt(5)
L_lv35b:
s_waitcnt vmcnt(6)
buffer_load_dwordx4 v4, s[32:35], s14 offen offset:2048 nt lds
s_cmp_eq_u32 s55, 2
s_cbranch_scc1 L_lv36b
s_waitcnt vmcnt(5)
L_lv36b:
s_waitcnt vmcnt(6)
buffer_load_dwordx4 v5, s[32:35], s14 offen offset:3072 nt lds
s_cmp_eq_u32 s55, 2
s_cbranch_scc1 L_lv37b
s_waitcnt vmcnt(5)
L_lv37b:
s_waitcnt vmcnt(6)
s_add_u32 m0, s10, 4096
s_add_u32 s14, s11, 409600
buffer_load_dwordx4 v6, s[32:35], s14 offen offset:0 nt lds
s_cmp_eq_u32 s55, 2
s_cbranch_scc1 L_lv38b
s_waitcnt vmcnt(5)
L_lv38b:
s_waitcnt vmcnt(6)
buffer_load_dwordx4 v7, s[32:35], s14 offen offset:1024 nt lds
s_cmp_eq_u32 s55, 2
s_cbranch_scc1 L_lv39b
s_waitcnt vmcnt(5)
L_lv39b:
s_waitcnt vmcnt(6)
buffer_load_dwordx4 v8, s[32:35], s14 offen offset:2048 nt lds
s_cmp_eq_u32 s55, 2
s_cbranch_scc1 L_lv40b
s_waitcnt vmcnt(5)
L_lv40b:
s_waitcnt vmcnt(6)
buffer_load_dwordx4 v9, s[32:35], s14 offen offset:3072 nt lds
ds_read_b128 v[128:131], v10 offset:24576
ds_read_b128 v[132:135], v11 offset:24576
ds_read_b128 v[136:139], v12 offset:24576
ds_read_b128 v[140:143], v13 offset:24576
ds_read_b128 v[144:147], v14 offset:24576
ds_read_b128 v[148:151], v15 offset:24576
ds_read_b128 v[152:155], v16 offset:24576
ds_read_b128 v[156:159], v17 offset:24576
s_waitcnt lgkmcnt(7)
v_mfma_f32_16x16x32_bf16 v[108:111], v[128:131], v[32:35], 0
s_waitcnt lgkmcnt(6)
v_mfma_f32_16x16x32_bf16 v[108:111], v[132:135], v[36:39], v[108:111]
s_waitcnt lgkmcnt(5)
v_mfma_f32_16x16x32_bf16 v[108:111], v[136:139], v[40:43], v[108:111]
s_waitcnt lgkmcnt(4)
v_mfma_f32_16x16x32_bf16 v[108:111], v[140:143], v[44:47], v[108:111]
s_waitcnt lgkmcnt(3)
v_mfma_f32_16x16x32_bf16 v[108:111], v[144:147], v[48:51], v[108:111]
s_waitcnt lgkmcnt(2)
v_mfma_f32_16x16x32_bf16 v[108:111], v[148:151], v[52:55], v[108:111]
s_waitcnt lgkmcnt(1)
v_mfma_f32_16x16x32_bf16 v[108:111], v[152:155], v[56:59], v[108:111]
s_waitcnt lgkmcnt(0)
v_mfma_f32_16x16x32_bf16 v[108:111], v[156:159], v[60:63], v[108:111]
v_cvt_pk_bf16_f32 v31, v104, v105
v_lshlrev_b32 v104, 16, v31
v_and_b32 v105, 0xffff0000, v31
v_cvt_pk_bf16_f32 v31, v106, v107
v_lshlrev_b32 v106, 16, v31
v_and_b32 v107, 0xffff0000, v31
s_cmp_eq_u32 s55, 2
s_cbranch_scc1 L_lv41b
s_waitcnt vmcnt(5)
L_lv41b:
s_waitcnt vmcnt(6)
s_add_u32 m0, s10, 8192
s_add_u32 s14, s11, 425984
buffer_load_dwordx4 v2, s[32:35], s14 offen offset:0 nt lds
s_cmp_eq_u32 s55, 2
s_cbranch_scc1 L_lv42b
s_waitcnt vmcnt(5)
L_lv42b:
s_waitcnt vmcnt(6)
buffer_load_dwordx4 v3, s[32:35], s14 offen offset:1024 nt lds
s_cmp_eq_u32 s55, 2
s_cbranch_scc1 L_lv43b
s_waitcnt vmcnt(5)
L_lv43b:
s_waitcnt vmcnt(6)
buffer_load_dwordx4 v4, s[32:35], s14 offen offset:2048 nt lds
s_cmp_eq_u32 s55, 2
s_cbranch_scc1 L_lv44b
s_waitcnt vmcnt(5)
L_lv44b:
s_waitcnt vmcnt(6)
buffer_load_dwordx4 v5, s[32:35], s14 offen offset:3072 nt lds
s_cmp_eq_u32 s55, 2
s_cbranch_scc1 L_lv45b
s_waitcnt vmcnt(5)
L_lv45b:
s_waitcnt vmcnt(6)
s_add_u32 m0, s10, 12288
s_add_u32 s14, s11, 442368
buffer_load_dwordx4 v6, s[32:35], s14 offen offset:0 nt lds
s_cmp_eq_u32 s55, 2
s_cbranch_scc1 L_lv46b
s_waitcnt vmcnt(5)
L_lv46b:
s_waitcnt vmcnt(6)
buffer_load_dwordx4 v7, s[32:35], s14 offen offset:1024 nt lds
s_cmp_eq_u32 s55, 2
s_cbranch_scc1 L_lv47b
s_waitcnt vmcnt(5)
L_lv47b:
s_waitcnt vmcnt(6)
buffer_load_dwordx4 v8, s[32:35], s14 offen offset:2048 nt lds
s_cmp_eq_u32 s55, 2
s_cbranch_scc1 L_lv48b
s_waitcnt vmcnt(5)
L_lv48b:
s_waitcnt vmcnt(6)
buffer_load_dwordx4 v9, s[32:35], s14 offen offset:3072 nt lds
ds_read_b128 v[128:131], v10 offset:0
ds_read_b128 v[132:135], v11 offset:0
ds_read_b128 v[136:139], v12 offset:0
ds_read_b128 v[140:143], v13 offset:0
ds_read_b128 v[144:147], v14 offset:0
ds_read_b128 v[148:151], v15 offset:0
ds_read_b128 v[152:155], v16 offset:0
ds_read_b128 v[156:159], v17 offset:0
s_waitcnt lgkmcnt(7)
v_mfma_f32_16x16x32_bf16 v[112:115], v[128:131], v[32:35], 0
s_waitcnt lgkmcnt(6)
v_mfma_f32_16x16x32_bf16 v[112:115], v[132:135], v[36:39], v[112:115]
s_waitcnt lgkmcnt(5)
v_mfma_f32_16x16x32_bf16 v[112:115], v[136:139], v[40:43], v[112:115]
s_waitcnt lgkmcnt(4)
v_mfma_f32_16x16x32_bf16 v[112:115], v[140:143], v[44:47], v[112:115]
s_waitcnt lgkmcnt(3)
v_mfma_f32_16x16x32_bf16 v[112:115], v[144:147], v[48:51], v[112:115]
s_waitcnt lgkmcnt(2)
v_mfma_f32_16x16x32_bf16 v[112:115], v[148:151], v[52:55], v[112:115]
s_waitcnt lgkmcnt(1)
v_mfma_f32_16x16x32_bf16 v[112:115], v[152:155], v[56:59], v[112:115]
s_waitcnt lgkmcnt(0)
v_mfma_f32_16x16x32_bf16 v[112:115], v[156:159], v[60:63], v[112:115]
v_cvt_pk_bf16_f32 v31, v108, v109
v_lshlrev_b32 v108, 16, v31
v_and_b32 v109, 0xffff0000, v31
v_cvt_pk_bf16_f32 v31, v110, v111
v_lshlrev_b32 v110, 16, v31
v_and_b32 v111, 0xffff0000, v31
s_cmp_eq_u32 s55, 2
s_cbranch_scc1 L_lv49b
s_waitcnt vmcnt(5)
L_lv49b:
s_waitcnt vmcnt(6)
s_add_u32 m0, s10, 16384
s_add_u32 s14, s11, 458752
buffer_load_dwordx4 v2, s[32:35], s14 offen offset:0 nt lds
s_cmp_eq_u32 s55, 2
s_cbranch_scc1 L_lv50b
s_waitcnt vmcnt(5)
L_lv50b:
s_waitcnt vmcnt(6)
buffer_load_dwordx4 v3, s[32:35], s14 offen offset:1024 nt lds
s_cmp_eq_u32 s55, 2
s_cbranch_scc1 L_lv51b
s_waitcnt vmcnt(5)
L_lv51b:
s_waitcnt vmcnt(6)
buffer_load_dwordx4 v4, s[32:35], s14 offen offset:2048 nt lds
s_cmp_eq_u32 s55, 2
s_cbranch_scc1 L_lv52b
s_waitcnt vmcnt(5)
L_lv52b:
s_waitcnt vmcnt(6)
buffer_load_dwordx4 v5, s[32:35], s14 offen offset:3072 nt lds
s_cmp_eq_u32 s55, 2
s_cbranch_scc1 L_lv53b
s_waitcnt vmcnt(5)
L_lv53b:
s_waitcnt vmcnt(6)
s_add_u32 m0, s10, 20480
s_add_u32 s14, s11, 475136
buffer_load_dwordx4 v6, s[32:35], s14 offen offset:0 nt lds
s_cmp_eq_u32 s55, 2
s_cbranch_scc1 L_lv54b
s_waitcnt vmcnt(5)
L_lv54b:
s_waitcnt vmcnt(6)
buffer_load_dwordx4 v7, s[32:35], s14 offen offset:1024 nt lds
s_cmp_eq_u32 s55, 2
s_cbranch_scc1 L_lv55b
s_waitcnt vmcnt(5)
L_lv55b:
s_waitcnt vmcnt(6)
buffer_load_dwordx4 v8, s[32:35], s14 offen offset:2048 nt lds
s_cmp_eq_u32 s55, 2
s_cbranch_scc1 L_lv56b
s_waitcnt vmcnt(5)
L_lv56b:
s_waitcnt vmcnt(6)
buffer_load_dwordx4 v9, s[32:35], s14 offen offset:3072 nt lds
ds_read_b128 v[128:131], v10 offset:8192
ds_read_b128 v[132:135], v11 offset:8192
ds_read_b128 v[136:139], v12 offset:8192
ds_read_b128 v[140:143], v13 offset:8192
ds_read_b128 v[144:147], v14 offset:8192
ds_read_b128 v[148:151], v15 offset:8192
ds_read_b128 v[152:155], v16 offset:8192
ds_read_b128 v[156:159], v17 offset:8192
s_waitcnt lgkmcnt(7)
v_mfma_f32_16x16x32_bf16 v[116:119], v[128:131], v[32:35], 0
s_waitcnt lgkmcnt(6)
v_mfma_f32_16x16x32_bf16 v[116:119], v[132:135], v[36:39], v[116:119]
s_waitcnt lgkmcnt(5)
v_mfma_f32_16x16x32_bf16 v[116:119], v[136:139], v[40:43], v[116:119]
s_waitcnt lgkmcnt(4)
v_mfma_f32_16x16x32_bf16 v[116:119], v[140:143], v[44:47], v[116:119]
s_waitcnt lgkmcnt(3)
v_mfma_f32_16x16x32_bf16 v[116:119], v[144:147], v[48:51], v[116:119]
s_waitcnt lgkmcnt(2)
v_mfma_f32_16x16x32_bf16 v[116:119], v[148:151], v[52:55], v[116:119]
s_waitcnt lgkmcnt(1)
v_mfma_f32_16x16x32_bf16 v[116:119], v[152:155], v[56:59], v[116:119]
s_waitcnt lgkmcnt(0)
v_mfma_f32_16x16x32_bf16 v[116:119], v[156:159], v[60:63], v[116:119]
v_cvt_pk_bf16_f32 v31, v112, v113
v_lshlrev_b32 v112, 16, v31
v_and_b32 v113, 0xffff0000, v31
v_cvt_pk_bf16_f32 v31, v114, v115
v_lshlrev_b32 v114, 16, v31
v_and_b32 v115, 0xffff0000, v31
s_cmp_eq_u32 s55, 2
s_cbranch_scc1 L_lv57b
s_waitcnt vmcnt(5)
L_lv57b:
s_waitcnt vmcnt(6)
s_add_u32 m0, s10, 24576
s_add_u32 s14, s11, 491520
buffer_load_dwordx4 v2, s[32:35], s14 offen offset:0 nt lds
s_cmp_eq_u32 s55, 2
s_cbranch_scc1 L_lv58b
s_waitcnt vmcnt(5)
L_lv58b:
s_waitcnt vmcnt(6)
buffer_load_dwordx4 v3, s[32:35], s14 offen offset:1024 nt lds
s_cmp_eq_u32 s55, 2
s_cbranch_scc1 L_lv59b
s_waitcnt vmcnt(5)
L_lv59b:
s_waitcnt vmcnt(6)
buffer_load_dwordx4 v4, s[32:35], s14 offen offset:2048 nt lds
s_cmp_eq_u32 s55, 2
s_cbranch_scc1 L_lv60b
s_waitcnt vmcnt(5)
L_lv60b:
s_waitcnt vmcnt(6)
buffer_load_dwordx4 v5, s[32:35], s14 offen offset:3072 nt lds
s_cmp_eq_u32 s55, 2
s_cbranch_scc1 L_lv61b
s_waitcnt vmcnt(5)
L_lv61b:
s_waitcnt vmcnt(6)
s_add_u32 m0, s10, 28672
s_add_u32 s14, s11, 507904
buffer_load_dwordx4 v6, s[32:35], s14 offen offset:0 nt lds
s_cmp_eq_u32 s55, 2
s_cbranch_scc1 L_lv62b
s_waitcnt vmcnt(5)
L_lv62b:
s_waitcnt vmcnt(6)
buffer_load_dwordx4 v7, s[32:35], s14 offen offset:1024 nt lds
s_cmp_eq_u32 s55, 2
s_cbranch_scc1 L_lv63b
s_waitcnt vmcnt(5)
L_lv63b:
s_waitcnt vmcnt(6)
buffer_load_dwordx4 v8, s[32:35], s14 offen offset:2048 nt lds
s_cmp_eq_u32 s55, 2
s_cbranch_scc1 L_lv64b
s_waitcnt vmcnt(5)
L_lv64b:
s_waitcnt vmcnt(6)
buffer_load_dwordx4 v9, s[32:35], s14 offen offset:3072 nt lds
ds_read_b128 v[128:131], v10 offset:16384
ds_read_b128 v[132:135], v11 offset:16384
ds_read_b128 v[136:139], v12 offset:16384
ds_read_b128 v[140:143], v13 offset:16384
ds_read_b128 v[144:147], v14 offset:16384
ds_read_b128 v[148:151], v15 offset:16384
ds_read_b128 v[152:155], v16 offset:16384
ds_read_b128 v[156:159], v17 offset:16384
s_waitcnt lgkmcnt(7)
v_mfma_f32_16x16x32_bf16 v[120:123], v[128:131], v[32:35], 0
s_waitcnt lgkmcnt(6)
v_mfma_f32_16x16x32_bf16 v[120:123], v[132:135], v[36:39], v[120:123]
s_waitcnt lgkmcnt(5)
v_mfma_f32_16x16x32_bf16 v[120:123], v[136:139], v[40:43], v[120:123]
s_waitcnt lgkmcnt(4)
v_mfma_f32_16x16x32_bf16 v[120:123], v[140:143], v[44:47], v[120:123]
s_waitcnt lgkmcnt(3)
v_mfma_f32_16x16x32_bf16 v[120:123], v[144:147], v[48:51], v[120:123]
s_waitcnt lgkmcnt(2)
v_mfma_f32_16x16x32_bf16 v[120:123], v[148:151], v[52:55], v[120:123]
s_waitcnt lgkmcnt(1)
v_mfma_f32_16x16x32_bf16 v[120:123], v[152:155], v[56:59], v[120:123]
s_waitcnt lgkmcnt(0)
v_mfma_f32_16x16x32_bf16 v[120:123], v[156:159], v[60:63], v[120:123]
v_cvt_pk_bf16_f32 v31, v116, v117
v_lshlrev_b32 v116, 16, v31
v_and_b32 v117, 0xffff0000, v31
v_cvt_pk_bf16_f32 v31, v118, v119
v_lshlrev_b32 v118, 16, v31
v_and_b32 v119, 0xffff0000, v31
s_cmp_eq_u32 s55, 2
s_cbranch_scc1 L_lv65b
s_waitcnt vmcnt(5)
L_lv65b:
s_waitcnt vmcnt(6)
s_add_u32 m0, s10, 0
s_add_u32 s14, s59, 0
buffer_load_dwordx4 v18, s[36:39], s14 offen offset:0 nt lds
s_cmp_eq_u32 s55, 2
s_cbranch_scc1 L_lv66b
s_waitcnt vmcnt(5)
L_lv66b:
s_waitcnt vmcnt(6)
buffer_load_dwordx4 v19, s[36:39], s14 offen offset:1024 nt lds
s_cmp_eq_u32 s55, 2
s_cbranch_scc1 L_lv67b
s_waitcnt vmcnt(5)
L_lv67b:
s_waitcnt vmcnt(6)
buffer_load_dwordx4 v20, s[36:39], s14 offen offset:2048 nt lds
s_cmp_eq_u32 s55, 2
s_cbranch_scc1 L_lv68b
s_waitcnt vmcnt(5)
L_lv68b:
s_waitcnt vmcnt(6)
buffer_load_dwordx4 v21, s[36:39], s14 offen offset:3072 nt lds
s_cmp_eq_u32 s55, 2
s_cbranch_scc1 L_lv69b
s_waitcnt vmcnt(5)
L_lv69b:
s_waitcnt vmcnt(6)
s_add_u32 m0, s10, 4096
s_add_u32 s14, s59, 16384
buffer_load_dwordx4 v18, s[36:39], s14 offen offset:0 nt lds
s_cmp_eq_u32 s55, 2
s_cbranch_scc1 L_lv70b
s_waitcnt vmcnt(5)
L_lv70b:
s_waitcnt vmcnt(6)
buffer_load_dwordx4 v19, s[36:39], s14 offen offset:1024 nt lds
s_cmp_eq_u32 s55, 2
s_cbranch_scc1 L_lv71b
s_waitcnt vmcnt(5)
L_lv71b:
s_waitcnt vmcnt(6)
buffer_load_dwordx4 v20, s[36:39], s14 offen offset:2048 nt lds
s_cmp_eq_u32 s55, 2
s_cbranch_scc1 L_lv72b
s_waitcnt vmcnt(5)
L_lv72b:
s_waitcnt vmcnt(6)
buffer_load_dwordx4 v21, s[36:39], s14 offen offset:3072 nt lds
ds_read_b128 v[128:131], v10 offset:24576
ds_read_b128 v[132:135], v11 offset:24576
ds_read_b128 v[136:139], v12 offset:24576
ds_read_b128 v[140:143], v13 offset:24576
ds_read_b128 v[144:147], v14 offset:24576
ds_read_b128 v[148:151], v15 offset:24576
ds_read_b128 v[152:155], v16 offset:24576
ds_read_b128 v[156:159], v17 offset:24576
s_waitcnt lgkmcnt(7)
v_mfma_f32_16x16x32_bf16 v[124:127], v[128:131], v[32:35], 0
s_waitcnt lgkmcnt(6)
v_mfma_f32_16x16x32_bf16 v[124:127], v[132:135], v[36:39], v[124:127]
s_waitcnt lgkmcnt(5)
v_mfma_f32_16x16x32_bf16 v[124:127], v[136:139], v[40:43], v[124:127]
s_waitcnt lgkmcnt(4)
v_mfma_f32_16x16x32_bf16 v[124:127], v[140:143], v[44:47], v[124:127]
s_waitcnt lgkmcnt(3)
v_mfma_f32_16x16x32_bf16 v[124:127], v[144:147], v[48:51], v[124:127]
s_waitcnt lgkmcnt(2)
v_mfma_f32_16x16x32_bf16 v[124:127], v[148:151], v[52:55], v[124:127]
s_waitcnt lgkmcnt(1)
v_mfma_f32_16x16x32_bf16 v[124:127], v[152:155], v[56:59], v[124:127]
s_waitcnt lgkmcnt(0)
v_mfma_f32_16x16x32_bf16 v[124:127], v[156:159], v[60:63], v[124:127]
v_cvt_pk_bf16_f32 v31, v120, v121
v_lshlrev_b32 v120, 16, v31
v_and_b32 v121, 0xffff0000, v31
v_cvt_pk_bf16_f32 v31, v122, v123
v_lshlrev_b32 v122, 16, v31
v_and_b32 v123, 0xffff0000, v31
s_add_u32 m0, s10, 8192
s_add_u32 s14, s59, 32768
buffer_load_dwordx4 v18, s[36:39], s14 offen offset:0 nt lds
s_nop 7
v_cvt_pk_bf16_f32 v31, v124, v125
v_lshlrev_b32 v124, 16, v31
v_and_b32 v125, 0xffff0000, v31
v_cvt_pk_bf16_f32 v31, v126, v127
v_lshlrev_b32 v126, 16, v31
v_and_b32 v127, 0xffff0000, v31
v_max3_f32 v164, v64, v65, v66
v_max3_f32 v164, v164, v67, v68
v_max3_f32 v164, v164, v69, v70
v_max3_f32 v164, v164, v71, v72
v_max3_f32 v164, v164, v73, v74
v_max3_f32 v164, v164, v75, v76
v_max3_f32 v164, v164, v77, v78
v_max3_f32 v164, v164, v79, v80
v_max3_f32 v164, v164, v81, v82
v_max3_f32 v164, v164, v83, v84
v_max3_f32 v164, v164, v85, v86
v_max3_f32 v164, v164, v87, v88
v_max3_f32 v164, v164, v89, v90
v_max3_f32 v164, v164, v91, v92
v_max3_f32 v164, v164, v93, v94
v_max3_f32 v164, v164, v95, v96
v_max3_f32 v164, v164, v97, v98
v_max3_f32 v164, v164, v99, v100
v_max3_f32 v164, v164, v101, v102
v_max3_f32 v164, v164, v103, v104
v_max3_f32 v164, v164, v105, v106
v_max3_f32 v164, v164, v107, v108
v_max3_f32 v164, v164, v109, v110
v_max3_f32 v164, v164, v111, v112
v_max3_f32 v164, v164, v113, v114
v_max3_f32 v164, v164, v115, v116
v_max3_f32 v164, v164, v117, v118
v_max3_f32 v164, v164, v119, v120
v_max3_f32 v164, v164, v121, v122
v_max3_f32 v164, v164, v123, v124
v_max3_f32 v164, v164, v125, v126
v_max_f32 v164, v164, v127
s_mov_b32 exec_lo, 0x00030003
s_mov_b32 exec_hi, 0x00030003
ds_write_b32 v30, v164
s_mov_b64 exec, -1
buffer_load_dwordx4 v19, s[36:39], s14 offen offset:1024 nt lds
s_cmp_eq_u32 s55, 2
s_cbranch_scc1 L_lv73b
s_waitcnt vmcnt(8)
L_lv73b:
buffer_load_dwordx4 v20, s[36:39], s14 offen offset:2048 nt lds
s_waitcnt lgkmcnt(0)
s_barrier
ds_read_b128 v[168:171], v29 offset:0
ds_read_b128 v[172:175], v29 offset:16
ds_read_b128 v[176:179], v29 offset:32
ds_read_b128 v[180:183], v29 offset:48
s_waitcnt lgkmcnt(0)
v_max3_f32 v164, v168, v169, v170
v_max3_f32 v164, v164, v171, v172
v_max3_f32 v164, v164, v173, v174
v_max3_f32 v164, v164, v175, v176
v_max3_f32 v164, v164, v177, v178
v_max3_f32 v164, v164, v179, v180
v_max3_f32 v164, v164, v181, v182
v_max_f32 v164, v164, v183
s_mov_b32 s15, 0x3db8aa3b
v_mul_f32 v165, s15, v164
v_mov_b32 v166, 0
v_mov_b32 v167, 0
v_fma_f32 v64, v64, s15, -v165
v_fma_f32 v65, v65, s15, -v165
v_fma_f32 v66, v66, s15, -v165
v_fma_f32 v67, v67, s15, -v165
v_exp_f32 v64, v64
v_exp_f32 v65, v65
v_exp_f32 v66, v66
v_exp_f32 v67, v67
v_fma_f32 v68, v68, s15, -v165
v_fma_f32 v69, v69, s15, -v165
v_fma_f32 v70, v70, s15, -v165
v_fma_f32 v71, v71, s15, -v165
v_exp_f32 v68, v68
v_exp_f32 v69, v69
v_exp_f32 v70, v70
v_exp_f32 v71, v71
s_cmp_eq_u32 s55, 2
s_cbranch_scc1 L_lv74b
s_waitcnt vmcnt(8)
L_lv74b:
s_waitcnt vmcnt(9)
buffer_load_dwordx4 v21, s[36:39], s14 offen offset:3072 nt lds
v_add_f32 v166, v166, v64
v_add_f32 v167, v167, v65
v_add_f32 v166, v166, v66
v_add_f32 v167, v167, v67
v_cvt_pk_bf16_f32 v64, v64, v65
v_cvt_pk_bf16_f32 v65, v66, v67
v_fma_f32 v72, v72, s15, -v165
v_fma_f32 v73, v73, s15, -v165
v_fma_f32 v74, v74, s15, -v165
v_fma_f32 v75, v75, s15, -v165
v_exp_f32 v72, v72
v_exp_f32 v73, v73
v_exp_f32 v74, v74
v_exp_f32 v75, v75
v_add_f32 v166, v166, v68
v_add_f32 v167, v167, v69
v_add_f32 v166, v166, v70
v_add_f32 v167, v167, v71
v_cvt_pk_bf16_f32 v68, v68, v69
v_cvt_pk_bf16_f32 v69, v70, v71
v_fma_f32 v76, v76, s15, -v165
v_fma_f32 v77, v77, s15, -v165
v_fma_f32 v78, v78, s15, -v165
v_fma_f32 v79, v79, s15, -v165
v_exp_f32 v76, v76
v_exp_f32 v77, v77
v_exp_f32 v78, v78
v_exp_f32 v79, v79
s_cmp_eq_u32 s55, 2
s_cbranch_scc1 L_lv75b
s_waitcnt vmcnt(8)
L_lv75b:
s_waitcnt vmcnt(9)
s_add_u32 m0, s10, 12288
s_add_u32 s14, s59, 49152
buffer_load_dwordx4 v18, s[36:39], s14 offen offset:0 nt lds
v_add_f32 v166, v166, v72
v_add_f32 v167, v167, v73
v_add_f32 v166, v166, v74
v_add_f32 v167, v167, v75
v_cvt_pk_bf16_f32 v72, v72, v73
v_cvt_pk_bf16_f32 v73, v74, v75
v_fma_f32 v80, v80, s15, -v165
v_fma_f32 v81, v81, s15, -v165
v_fma_f32 v82, v82, s15, -v165
v_fma_f32 v83, v83, s15, -v165
v_exp_f32 v80, v80
v_exp_f32 v81, v81
v_exp_f32 v82, v82
v_exp_f32 v83, v83
v_add_f32 v166, v166, v76
v_add_f32 v167, v167, v77
v_add_f32 v166, v166, v78
v_add_f32 v167, v167, v79
v_cvt_pk_bf16_f32 v76, v76, v77
v_cvt_pk_bf16_f32 v77, v78, v79
v_fma_f32 v84, v84, s15, -v165
v_fma_f32 v85, v85, s15, -v165
v_fma_f32 v86, v86, s15, -v165
v_fma_f32 v87, v87, s15, -v165
v_exp_f32 v84, v84
v_exp_f32 v85, v85
v_exp_f32 v86, v86
v_exp_f32 v87, v87
s_cmp_eq_u32 s55, 2
s_cbranch_scc1 L_lv76b
s_waitcnt vmcnt(8)
L_lv76b:
s_waitcnt vmcnt(9)
buffer_load_dwordx4 v19, s[36:39], s14 offen offset:1024 nt lds
v_add_f32 v166, v166, v80
v_add_f32 v167, v167, v81
v_add_f32 v166, v166, v82
v_add_f32 v167, v167, v83
v_cvt_pk_bf16_f32 v80, v80, v81
v_cvt_pk_bf16_f32 v81, v82, v83
v_fma_f32 v88, v88, s15, -v165
v_fma_f32 v89, v89, s15, -v165
v_fma_f32 v90, v90, s15, -v165
v_fma_f32 v91, v91, s15, -v165
v_exp_f32 v88, v88
v_exp_f32 v89, v89
v_exp_f32 v90, v90
v_exp_f32 v91, v91
v_add_f32 v166, v166, v84
v_add_f32 v167, v167, v85
v_add_f32 v166, v166, v86
v_add_f32 v167, v167, v87
v_cvt_pk_bf16_f32 v84, v84, v85
v_cvt_pk_bf16_f32 v85, v86, v87
v_fma_f32 v92, v92, s15, -v165
v_fma_f32 v93, v93, s15, -v165
v_fma_f32 v94, v94, s15, -v165
v_fma_f32 v95, v95, s15, -v165
v_exp_f32 v92, v92
v_exp_f32 v93, v93
v_exp_f32 v94, v94
v_exp_f32 v95, v95
s_cmp_eq_u32 s55, 2
s_cbranch_scc1 L_lv77b
s_waitcnt vmcnt(8)
L_lv77b:
s_waitcnt vmcnt(9)
buffer_load_dwordx4 v20, s[36:39], s14 offen offset:2048 nt lds
v_add_f32 v166, v166, v88
v_add_f32 v167, v167, v89
v_add_f32 v166, v166, v90
v_add_f32 v167, v167, v91
v_cvt_pk_bf16_f32 v88, v88, v89
v_cvt_pk_bf16_f32 v89, v90, v91
v_fma_f32 v96, v96, s15, -v165
v_fma_f32 v97, v97, s15, -v165
v_fma_f32 v98, v98, s15, -v165
v_fma_f32 v99, v99, s15, -v165
v_exp_f32 v96, v96
v_exp_f32 v97, v97
v_exp_f32 v98, v98
v_exp_f32 v99, v99
v_add_f32 v166, v166, v92
v_add_f32 v167, v167, v93
v_add_f32 v166, v166, v94
v_add_f32 v167, v167, v95
v_cvt_pk_bf16_f32 v92, v92, v93
v_cvt_pk_bf16_f32 v93, v94, v95
v_fma_f32 v100, v100, s15, -v165
v_fma_f32 v101, v101, s15, -v165
v_fma_f32 v102, v102, s15, -v165
v_fma_f32 v103, v103, s15, -v165
v_exp_f32 v100, v100
v_exp_f32 v101, v101
v_exp_f32 v102, v102
v_exp_f32 v103, v103
s_cmp_eq_u32 s55, 2
s_cbranch_scc1 L_lv78b
s_waitcnt vmcnt(8)
L_lv78b:
s_waitcnt vmcnt(9)
buffer_load_dwordx4 v21, s[36:39], s14 offen offset:3072 nt lds
v_add_f32 v166, v166, v96
v_add_f32 v167, v167, v97
v_add_f32 v166, v166, v98
v_add_f32 v167, v167, v99
v_cvt_pk_bf16_f32 v96, v96, v97
v_cvt_pk_bf16_f32 v97, v98, v99
v_fma_f32 v104, v104, s15, -v165
v_fma_f32 v105, v105, s15, -v165
v_fma_f32 v106, v106, s15, -v165
v_fma_f32 v107, v107, s15, -v165
v_exp_f32 v104, v104
v_exp_f32 v105, v105
v_exp_f32 v106, v106
v_exp_f32 v107, v107
v_add_f32 v166, v166, v100
v_add_f32 v167, v167, v101
v_add_f32 v166, v166, v102
v_add_f32 v167, v167, v103
v_cvt_pk_bf16_f32 v100, v100, v101
v_cvt_pk_bf16_f32 v101, v102, v103
v_fma_f32 v108, v108, s15, -v165
v_fma_f32 v109, v109, s15, -v165
v_fma_f32 v110, v110, s15, -v165
v_fma_f32 v111, v111, s15, -v165
v_exp_f32 v108, v108
v_exp_f32 v109, v109
v_exp_f32 v110, v110
v_exp_f32 v111, v111
s_cmp_eq_u32 s55, 2
s_cbranch_scc1 L_lv79b
s_waitcnt vmcnt(8)
L_lv79b:
s_waitcnt vmcnt(9)
s_add_u32 m0, s10, 16384
s_add_u32 s14, s59, 65536
buffer_load_dwordx4 v18, s[36:39], s14 offen offset:0 nt lds
v_add_f32 v166, v166, v104
v_add_f32 v167, v167, v105
v_add_f32 v166, v166, v106
v_add_f32 v167, v167, v107
v_cvt_pk_bf16_f32 v104, v104, v105
v_cvt_pk_bf16_f32 v105, v106, v107
v_fma_f32 v112, v112, s15, -v165
v_fma_f32 v113, v113, s15, -v165
v_fma_f32 v114, v114, s15, -v165
v_fma_f32 v115, v115, s15, -v165
v_exp_f32 v112, v112
v_exp_f32 v113, v113
v_exp_f32 v114, v114
v_exp_f32 v115, v115
v_add_f32 v166, v166, v108
v_add_f32 v167, v167, v109
v_add_f32 v166, v166, v110
v_add_f32 v167, v167, v111
v_cvt_pk_bf16_f32 v108, v108, v109
v_cvt_pk_bf16_f32 v109, v110, v111
v_fma_f32 v116, v116, s15, -v165
v_fma_f32 v117, v117, s15, -v165
v_fma_f32 v118, v118, s15, -v165
v_fma_f32 v119, v119, s15, -v165
v_exp_f32 v116, v116
v_exp_f32 v117, v117
v_exp_f32 v118, v118
v_exp_f32 v119, v119
s_cmp_eq_u32 s55, 2
s_cbranch_scc1 L_lv80b
s_waitcnt vmcnt(8)
L_lv80b:
s_waitcnt vmcnt(9)
buffer_load_dwordx4 v19, s[36:39], s14 offen offset:1024 nt lds
v_add_f32 v166, v166, v112
v_add_f32 v167, v167, v113
v_add_f32 v166, v166, v114
v_add_f32 v167, v167, v115
v_cvt_pk_bf16_f32 v112, v112, v113
v_cvt_pk_bf16_f32 v113, v114, v115
v_fma_f32 v120, v120, s15, -v165
v_fma_f32 v121, v121, s15, -v165
v_fma_f32 v122, v122, s15, -v165
v_fma_f32 v123, v123, s15, -v165
v_exp_f32 v120, v120
v_exp_f32 v121, v121
v_exp_f32 v122, v122
v_exp_f32 v123, v123
v_add_f32 v166, v166, v116
v_add_f32 v167, v167, v117
v_add_f32 v166, v166, v118
v_add_f32 v167, v167, v119
v_cvt_pk_bf16_f32 v116, v116, v117
v_cvt_pk_bf16_f32 v117, v118, v119
v_fma_f32 v124, v124, s15, -v165
v_fma_f32 v125, v125, s15, -v165
v_fma_f32 v126, v126, s15, -v165
v_fma_f32 v127, v127, s15, -v165
v_exp_f32 v124, v124
v_exp_f32 v125, v125
v_exp_f32 v126, v126
v_exp_f32 v127, v127
s_cmp_eq_u32 s55, 2
s_cbranch_scc1 L_lv81b
s_waitcnt vmcnt(8)
L_lv81b:
s_waitcnt vmcnt(9)
buffer_load_dwordx4 v20, s[36:39], s14 offen offset:2048 nt lds
v_add_f32 v166, v166, v120
v_add_f32 v167, v167, v121
v_add_f32 v166, v166, v122
v_add_f32 v167, v167, v123
v_cvt_pk_bf16_f32 v120, v120, v121
v_cvt_pk_bf16_f32 v121, v122, v123
s_nop 0
v_add_f32 v166, v166, v124
v_add_f32 v167, v167, v125
v_add_f32 v166, v166, v126
v_add_f32 v167, v167, v127
v_cvt_pk_bf16_f32 v124, v124, v125
v_cvt_pk_bf16_f32 v125, v126, v127
v_add_f32 v166, v166, v167
s_mov_b32 exec_lo, 0x00030003
s_mov_b32 exec_hi, 0x00030003
ds_write_b64 v27, v[64:65] offset:0
ds_write_b64 v27, v[68:69] offset:128
ds_write_b64 v27, v[72:73] offset:256
ds_write_b64 v27, v[76:77] offset:384
ds_write_b64 v27, v[80:81] offset:512
ds_write_b64 v27, v[84:85] offset:640
ds_write_b64 v27, v[88:89] offset:768
ds_write_b64 v27, v[92:93] offset:896
ds_write_b64 v27, v[96:97] offset:1024
ds_write_b64 v27, v[100:101] offset:1152
ds_write_b64 v27, v[104:105] offset:1280
ds_write_b64 v27, v[108:109] offset:1408
ds_write_b64 v27, v[112:113] offset:1536
ds_write_b64 v27, v[116:117] offset:1664
ds_write_b64 v27, v[120:121] offset:1792
ds_write_b64 v27, v[124:125] offset:1920
ds_write_b32 v30, v166 offset:128
s_mov_b64 exec, -1
v_mov_b32 v148, 0
v_mov_b32 v149, 0
v_mov_b32 v150, 0
v_mov_b32 v151, 0
v_mov_b32 v152, 0
v_mov_b32 v153, 0
v_mov_b32 v154, 0
v_mov_b32 v155, 0
v_mov_b32 v156, 0
v_mov_b32 v157, 0
v_mov_b32 v158, 0
v_mov_b32 v159, 0
v_mov_b32 v160, 0
v_mov_b32 v161, 0
v_mov_b32 v162, 0
v_mov_b32 v163, 0
s_cmp_eq_u32 s55, 2
s_cbranch_scc1 L_lv82b
s_waitcnt vmcnt(8)
L_lv82b:
s_waitcnt vmcnt(9)
buffer_load_dwordx4 v21, s[36:39], s14 offen offset:3072 nt lds
s_cmp_eq_u32 s55, 2
s_cbranch_scc1 L_lv83b
s_waitcnt vmcnt(8)
L_lv83b:
s_waitcnt vmcnt(9)
s_add_u32 m0, s10, 20480
s_add_u32 s14, s59, 81920
buffer_load_dwordx4 v18, s[36:39], s14 offen offset:0 nt lds
s_waitcnt lgkmcnt(0)
s_barrier
ds_read_b128 v[128:131], v26 offset:0
ds_read_b64_tr_b16 v[132:133], v22 offset:0
ds_read_b64_tr_b16 v[134:135], v22 offset:1024
ds_read_b64_tr_b16 v[136:137], v23 offset:0
ds_read_b64_tr_b16 v[138:139], v23 offset:1024
ds_read_b64_tr_b16 v[140:141], v24 offset:0
ds_read_b64_tr_b16 v[142:143], v24 offset:1024
ds_read_b64_tr_b16 v[144:145], v25 offset:0
ds_read_b64_tr_b16 v[146:147], v25 offset:1024
s_waitcnt lgkmcnt(6)
v_mfma_f32_16x16x32_bf16 v[148:151], v[128:131], v[132:135], v[148:151]
s_waitcnt lgkmcnt(4)
v_mfma_f32_16x16x32_bf16 v[152:155], v[128:131], v[136:139], v[152:155]
s_waitcnt lgkmcnt(2)
v_mfma_f32_16x16x32_bf16 v[156:159], v[128:131], v[140:143], v[156:159]
s_waitcnt lgkmcnt(0)
v_mfma_f32_16x16x32_bf16 v[160:163], v[128:131], v[144:147], v[160:163]
ds_read_b128 v[128:131], v26 offset:64
ds_read_b64_tr_b16 v[132:133], v22 offset:4096
ds_read_b64_tr_b16 v[134:135], v22 offset:5120
ds_read_b64_tr_b16 v[136:137], v23 offset:4096
ds_read_b64_tr_b16 v[138:139], v23 offset:5120
ds_read_b64_tr_b16 v[140:141], v24 offset:4096
ds_read_b64_tr_b16 v[142:143], v24 offset:5120
ds_read_b64_tr_b16 v[144:145], v25 offset:4096
ds_read_b64_tr_b16 v[146:147], v25 offset:5120
s_waitcnt lgkmcnt(6)
v_mfma_f32_16x16x32_bf16 v[148:151], v[128:131], v[132:135], v[148:151]
s_waitcnt lgkmcnt(4)
v_mfma_f32_16x16x32_bf16 v[152:155], v[128:131], v[136:139], v[152:155]
s_waitcnt lgkmcnt(2)
v_mfma_f32_16x16x32_bf16 v[156:159], v[128:131], v[140:143], v[156:159]
s_waitcnt lgkmcnt(0)
v_mfma_f32_16x16x32_bf16 v[160:163], v[128:131], v[144:147], v[160:163]
s_waitcnt vmcnt(5)
buffer_load_dwordx4 v19, s[36:39], s14 offen offset:1024 nt lds
s_waitcnt vmcnt(5)
buffer_load_dwordx4 v20, s[36:39], s14 offen offset:2048 nt lds
s_waitcnt vmcnt(5)
buffer_load_dwordx4 v21, s[36:39], s14 offen offset:3072 nt lds
ds_read_b128 v[128:131], v26 offset:128
ds_read_b64_tr_b16 v[132:133], v22 offset:8192
ds_read_b64_tr_b16 v[134:135], v22 offset:9216
ds_read_b64_tr_b16 v[136:137], v23 offset:8192
ds_read_b64_tr_b16 v[138:139], v23 offset:9216
ds_read_b64_tr_b16 v[140:141], v24 offset:8192
ds_read_b64_tr_b16 v[142:143], v24 offset:9216
ds_read_b64_tr_b16 v[144:145], v25 offset:8192
ds_read_b64_tr_b16 v[146:147], v25 offset:9216
s_waitcnt lgkmcnt(6)
v_mfma_f32_16x16x32_bf16 v[148:151], v[128:131], v[132:135], v[148:151]
s_waitcnt lgkmcnt(4)
v_mfma_f32_16x16x32_bf16 v[152:155], v[128:131], v[136:139], v[152:155]
s_waitcnt lgkmcnt(2)
v_mfma_f32_16x16x32_bf16 v[156:159], v[128:131], v[140:143], v[156:159]
s_waitcnt lgkmcnt(0)
v_mfma_f32_16x16x32_bf16 v[160:163], v[128:131], v[144:147], v[160:163]
s_waitcnt vmcnt(5)
s_add_u32 m0, s10, 24576
s_add_u32 s14, s59, 98304
buffer_load_dwordx4 v18, s[36:39], s14 offen offset:0 nt lds
s_waitcnt vmcnt(5)
buffer_load_dwordx4 v19, s[36:39], s14 offen offset:1024 nt lds
s_waitcnt vmcnt(5)
buffer_load_dwordx4 v20, s[36:39], s14 offen offset:2048 nt lds
s_waitcnt vmcnt(5)
buffer_load_dwordx4 v21, s[36:39], s14 offen offset:3072 nt lds
ds_read_b128 v[128:131], v26 offset:192
ds_read_b64_tr_b16 v[132:133], v22 offset:12288
ds_read_b64_tr_b16 v[134:135], v22 offset:13312
ds_read_b64_tr_b16 v[136:137], v23 offset:12288
ds_read_b64_tr_b16 v[138:139], v23 offset:13312
ds_read_b64_tr_b16 v[140:141], v24 offset:12288
ds_read_b64_tr_b16 v[142:143], v24 offset:13312
ds_read_b64_tr_b16 v[144:145], v25 offset:12288
ds_read_b64_tr_b16 v[146:147], v25 offset:13312
s_waitcnt lgkmcnt(6)
v_mfma_f32_16x16x32_bf16 v[148:151], v[128:131], v[132:135], v[148:151]
s_waitcnt lgkmcnt(4)
v_mfma_f32_16x16x32_bf16 v[152:155], v[128:131], v[136:139], v[152:155]
s_waitcnt lgkmcnt(2)
v_mfma_f32_16x16x32_bf16 v[156:159], v[128:131], v[140:143], v[156:159]
s_waitcnt lgkmcnt(0)
v_mfma_f32_16x16x32_bf16 v[160:163], v[128:131], v[144:147], v[160:163]
s_waitcnt vmcnt(5)
s_add_u32 m0, s10, 28672
s_add_u32 s14, s59, 114688
buffer_load_dwordx4 v18, s[36:39], s14 offen offset:0 nt lds
s_waitcnt vmcnt(5)
buffer_load_dwordx4 v19, s[36:39], s14 offen offset:1024 nt lds
s_waitcnt vmcnt(5)
buffer_load_dwordx4 v20, s[36:39], s14 offen offset:2048 nt lds
s_waitcnt vmcnt(5)
buffer_load_dwordx4 v21, s[36:39], s14 offen offset:3072 nt lds
ds_read_b128 v[128:131], v26 offset:256
ds_read_b64_tr_b16 v[132:133], v22 offset:16384
ds_read_b64_tr_b16 v[134:135], v22 offset:17408
ds_read_b64_tr_b16 v[136:137], v23 offset:16384
ds_read_b64_tr_b16 v[138:139], v23 offset:17408
ds_read_b64_tr_b16 v[140:141], v24 offset:16384
ds_read_b64_tr_b16 v[142:143], v24 offset:17408
ds_read_b64_tr_b16 v[144:145], v25 offset:16384
ds_read_b64_tr_b16 v[146:147], v25 offset:17408
s_waitcnt lgkmcnt(6)
v_mfma_f32_16x16x32_bf16 v[148:151], v[128:131], v[132:135], v[148:151]
s_waitcnt lgkmcnt(4)
v_mfma_f32_16x16x32_bf16 v[152:155], v[128:131], v[136:139], v[152:155]
s_waitcnt lgkmcnt(2)
v_mfma_f32_16x16x32_bf16 v[156:159], v[128:131], v[140:143], v[156:159]
s_waitcnt lgkmcnt(0)
v_mfma_f32_16x16x32_bf16 v[160:163], v[128:131], v[144:147], v[160:163]
s_waitcnt vmcnt(5)
s_add_u32 m0, s10, 0
s_add_u32 s14, s59, 131072
buffer_load_dwordx4 v18, s[36:39], s14 offen offset:0 nt lds
s_waitcnt vmcnt(5)
buffer_load_dwordx4 v19, s[36:39], s14 offen offset:1024 nt lds
s_waitcnt vmcnt(5)
buffer_load_dwordx4 v20, s[36:39], s14 offen offset:2048 nt lds
s_waitcnt vmcnt(5)
buffer_load_dwordx4 v21, s[36:39], s14 offen offset:3072 nt lds
ds_read_b128 v[128:131], v26 offset:320
ds_read_b64_tr_b16 v[132:133], v22 offset:20480
ds_read_b64_tr_b16 v[134:135], v22 offset:21504
ds_read_b64_tr_b16 v[136:137], v23 offset:20480
ds_read_b64_tr_b16 v[138:139], v23 offset:21504
ds_read_b64_tr_b16 v[140:141], v24 offset:20480
ds_read_b64_tr_b16 v[142:143], v24 offset:21504
ds_read_b64_tr_b16 v[144:145], v25 offset:20480
ds_read_b64_tr_b16 v[146:147], v25 offset:21504
s_waitcnt lgkmcnt(6)
v_mfma_f32_16x16x32_bf16 v[148:151], v[128:131], v[132:135], v[148:151]
s_waitcnt lgkmcnt(4)
v_mfma_f32_16x16x32_bf16 v[152:155], v[128:131], v[136:139], v[152:155]
s_waitcnt lgkmcnt(2)
v_mfma_f32_16x16x32_bf16 v[156:159], v[128:131], v[140:143], v[156:159]
s_waitcnt lgkmcnt(0)
v_mfma_f32_16x16x32_bf16 v[160:163], v[128:131], v[144:147], v[160:163]
s_waitcnt vmcnt(5)
s_add_u32 m0, s10, 4096
s_add_u32 s14, s59, 147456
buffer_load_dwordx4 v18, s[36:39], s14 offen offset:0 nt lds
s_waitcnt vmcnt(5)
buffer_load_dwordx4 v19, s[36:39], s14 offen offset:1024 nt lds
s_waitcnt vmcnt(5)
buffer_load_dwordx4 v20, s[36:39], s14 offen offset:2048 nt lds
s_waitcnt vmcnt(5)
buffer_load_dwordx4 v21, s[36:39], s14 offen offset:3072 nt lds
ds_read_b128 v[128:131], v26 offset:384
ds_read_b64_tr_b16 v[132:133], v22 offset:24576
ds_read_b64_tr_b16 v[134:135], v22 offset:25600
ds_read_b64_tr_b16 v[136:137], v23 offset:24576
ds_read_b64_tr_b16 v[138:139], v23 offset:25600
ds_read_b64_tr_b16 v[140:141], v24 offset:24576
ds_read_b64_tr_b16 v[142:143], v24 offset:25600
ds_read_b64_tr_b16 v[144:145], v25 offset:24576
ds_read_b64_tr_b16 v[146:147], v25 offset:25600
s_waitcnt lgkmcnt(6)
v_mfma_f32_16x16x32_bf16 v[148:151], v[128:131], v[132:135], v[148:151]
s_waitcnt lgkmcnt(4)
v_mfma_f32_16x16x32_bf16 v[152:155], v[128:131], v[136:139], v[152:155]
s_waitcnt lgkmcnt(2)
v_mfma_f32_16x16x32_bf16 v[156:159], v[128:131], v[140:143], v[156:159]
s_waitcnt lgkmcnt(0)
v_mfma_f32_16x16x32_bf16 v[160:163], v[128:131], v[144:147], v[160:163]
s_waitcnt vmcnt(5)
s_add_u32 m0, s10, 8192
s_add_u32 s14, s59, 163840
buffer_load_dwordx4 v18, s[36:39], s14 offen offset:0 nt lds
s_waitcnt vmcnt(5)
buffer_load_dwordx4 v19, s[36:39], s14 offen offset:1024 nt lds
s_waitcnt vmcnt(5)
buffer_load_dwordx4 v20, s[36:39], s14 offen offset:2048 nt lds
s_waitcnt vmcnt(5)
buffer_load_dwordx4 v21, s[36:39], s14 offen offset:3072 nt lds
ds_read_b128 v[128:131], v26 offset:448
ds_read_b64_tr_b16 v[132:133], v22 offset:28672
ds_read_b64_tr_b16 v[134:135], v22 offset:29696
ds_read_b64_tr_b16 v[136:137], v23 offset:28672
ds_read_b64_tr_b16 v[138:139], v23 offset:29696
ds_read_b64_tr_b16 v[140:141], v24 offset:28672
ds_read_b64_tr_b16 v[142:143], v24 offset:29696
ds_read_b64_tr_b16 v[144:145], v25 offset:28672
ds_read_b64_tr_b16 v[146:147], v25 offset:29696
s_waitcnt lgkmcnt(6)
v_mfma_f32_16x16x32_bf16 v[148:151], v[128:131], v[132:135], v[148:151]
s_waitcnt lgkmcnt(4)
v_mfma_f32_16x16x32_bf16 v[152:155], v[128:131], v[136:139], v[152:155]
s_waitcnt lgkmcnt(2)
v_mfma_f32_16x16x32_bf16 v[156:159], v[128:131], v[140:143], v[156:159]
s_waitcnt lgkmcnt(0)
v_mfma_f32_16x16x32_bf16 v[160:163], v[128:131], v[144:147], v[160:163]
s_waitcnt vmcnt(5)
s_add_u32 m0, s10, 12288
s_add_u32 s14, s59, 180224
buffer_load_dwordx4 v18, s[36:39], s14 offen offset:0 nt lds
s_waitcnt vmcnt(5)
buffer_load_dwordx4 v19, s[36:39], s14 offen offset:1024 nt lds
s_waitcnt vmcnt(5)
buffer_load_dwordx4 v20, s[36:39], s14 offen offset:2048 nt lds
s_waitcnt vmcnt(5)
buffer_load_dwordx4 v21, s[36:39], s14 offen offset:3072 nt lds
ds_read_b128 v[128:131], v26 offset:512
ds_read_b64_tr_b16 v[132:133], v22 offset:0
ds_read_b64_tr_b16 v[134:135], v22 offset:1024
ds_read_b64_tr_b16 v[136:137], v23 offset:0
ds_read_b64_tr_b16 v[138:139], v23 offset:1024
ds_read_b64_tr_b16 v[140:141], v24 offset:0
ds_read_b64_tr_b16 v[142:143], v24 offset:1024
ds_read_b64_tr_b16 v[144:145], v25 offset:0
ds_read_b64_tr_b16 v[146:147], v25 offset:1024
s_waitcnt lgkmcnt(6)
v_mfma_f32_16x16x32_bf16 v[148:151], v[128:131], v[132:135], v[148:151]
s_waitcnt lgkmcnt(4)
v_mfma_f32_16x16x32_bf16 v[152:155], v[128:131], v[136:139], v[152:155]
s_waitcnt lgkmcnt(2)
v_mfma_f32_16x16x32_bf16 v[156:159], v[128:131], v[140:143], v[156:159]
s_waitcnt lgkmcnt(0)
v_mfma_f32_16x16x32_bf16 v[160:163], v[128:131], v[144:147], v[160:163]
s_waitcnt vmcnt(5)
s_add_u32 m0, s10, 16384
s_add_u32 s14, s59, 196608
buffer_load_dwordx4 v18, s[36:39], s14 offen offset:0 nt lds
s_waitcnt vmcnt(5)
buffer_load_dwordx4 v19, s[36:39], s14 offen offset:1024 nt lds
s_waitcnt vmcnt(5)
buffer_load_dwordx4 v20, s[36:39], s14 offen offset:2048 nt lds
s_waitcnt vmcnt(5)
buffer_load_dwordx4 v21, s[36:39], s14 offen offset:3072 nt lds
ds_read_b128 v[128:131], v26 offset:576
ds_read_b64_tr_b16 v[132:133], v22 offset:4096
ds_read_b64_tr_b16 v[134:135], v22 offset:5120
ds_read_b64_tr_b16 v[136:137], v23 offset:4096
ds_read_b64_tr_b16 v[138:139], v23 offset:5120
ds_read_b64_tr_b16 v[140:141], v24 offset:4096
ds_read_b64_tr_b16 v[142:143], v24 offset:5120
ds_read_b64_tr_b16 v[144:145], v25 offset:4096
ds_read_b64_tr_b16 v[146:147], v25 offset:5120
s_waitcnt lgkmcnt(6)
v_mfma_f32_16x16x32_bf16 v[148:151], v[128:131], v[132:135], v[148:151]
s_waitcnt lgkmcnt(4)
v_mfma_f32_16x16x32_bf16 v[152:155], v[128:131], v[136:139], v[152:155]
s_waitcnt lgkmcnt(2)
v_mfma_f32_16x16x32_bf16 v[156:159], v[128:131], v[140:143], v[156:159]
s_waitcnt lgkmcnt(0)
v_mfma_f32_16x16x32_bf16 v[160:163], v[128:131], v[144:147], v[160:163]
s_waitcnt vmcnt(5)
s_add_u32 m0, s10, 20480
s_add_u32 s14, s59, 212992
buffer_load_dwordx4 v18, s[36:39], s14 offen offset:0 nt lds
s_waitcnt vmcnt(5)
buffer_load_dwordx4 v19, s[36:39], s14 offen offset:1024 nt lds
s_waitcnt vmcnt(5)
buffer_load_dwordx4 v20, s[36:39], s14 offen offset:2048 nt lds
s_waitcnt vmcnt(5)
buffer_load_dwordx4 v21, s[36:39], s14 offen offset:3072 nt lds
ds_read_b128 v[128:131], v26 offset:640
ds_read_b64_tr_b16 v[132:133], v22 offset:8192
ds_read_b64_tr_b16 v[134:135], v22 offset:9216
ds_read_b64_tr_b16 v[136:137], v23 offset:8192
ds_read_b64_tr_b16 v[138:139], v23 offset:9216
ds_read_b64_tr_b16 v[140:141], v24 offset:8192
ds_read_b64_tr_b16 v[142:143], v24 offset:9216
ds_read_b64_tr_b16 v[144:145], v25 offset:8192
ds_read_b64_tr_b16 v[146:147], v25 offset:9216
s_waitcnt lgkmcnt(6)
v_mfma_f32_16x16x32_bf16 v[148:151], v[128:131], v[132:135], v[148:151]
s_waitcnt lgkmcnt(4)
v_mfma_f32_16x16x32_bf16 v[152:155], v[128:131], v[136:139], v[152:155]
s_waitcnt lgkmcnt(2)
v_mfma_f32_16x16x32_bf16 v[156:159], v[128:131], v[140:143], v[156:159]
s_waitcnt lgkmcnt(0)
v_mfma_f32_16x16x32_bf16 v[160:163], v[128:131], v[144:147], v[160:163]
s_waitcnt vmcnt(5)
s_add_u32 m0, s10, 24576
s_add_u32 s14, s59, 229376
buffer_load_dwordx4 v18, s[36:39], s14 offen offset:0 nt lds
s_waitcnt vmcnt(5)
buffer_load_dwordx4 v19, s[36:39], s14 offen offset:1024 nt lds
s_waitcnt vmcnt(5)
buffer_load_dwordx4 v20, s[36:39], s14 offen offset:2048 nt lds
s_waitcnt vmcnt(5)
buffer_load_dwordx4 v21, s[36:39], s14 offen offset:3072 nt lds
ds_read_b128 v[128:131], v26 offset:704
ds_read_b64_tr_b16 v[132:133], v22 offset:12288
ds_read_b64_tr_b16 v[134:135], v22 offset:13312
ds_read_b64_tr_b16 v[136:137], v23 offset:12288
ds_read_b64_tr_b16 v[138:139], v23 offset:13312
ds_read_b64_tr_b16 v[140:141], v24 offset:12288
ds_read_b64_tr_b16 v[142:143], v24 offset:13312
ds_read_b64_tr_b16 v[144:145], v25 offset:12288
ds_read_b64_tr_b16 v[146:147], v25 offset:13312
s_waitcnt lgkmcnt(6)
v_mfma_f32_16x16x32_bf16 v[148:151], v[128:131], v[132:135], v[148:151]
s_waitcnt lgkmcnt(4)
v_mfma_f32_16x16x32_bf16 v[152:155], v[128:131], v[136:139], v[152:155]
s_waitcnt lgkmcnt(2)
v_mfma_f32_16x16x32_bf16 v[156:159], v[128:131], v[140:143], v[156:159]
s_waitcnt lgkmcnt(0)
v_mfma_f32_16x16x32_bf16 v[160:163], v[128:131], v[144:147], v[160:163]
s_waitcnt vmcnt(5)
s_add_u32 m0, s10, 28672
s_add_u32 s14, s59, 245760
buffer_load_dwordx4 v18, s[36:39], s14 offen offset:0 nt lds
s_waitcnt vmcnt(5)
buffer_load_dwordx4 v19, s[36:39], s14 offen offset:1024 nt lds
s_waitcnt vmcnt(5)
buffer_load_dwordx4 v20, s[36:39], s14 offen offset:2048 nt lds
s_waitcnt vmcnt(5)
buffer_load_dwordx4 v21, s[36:39], s14 offen offset:3072 nt lds
ds_read_b128 v[128:131], v26 offset:768
ds_read_b64_tr_b16 v[132:133], v22 offset:16384
ds_read_b64_tr_b16 v[134:135], v22 offset:17408
ds_read_b64_tr_b16 v[136:137], v23 offset:16384
ds_read_b64_tr_b16 v[138:139], v23 offset:17408
ds_read_b64_tr_b16 v[140:141], v24 offset:16384
ds_read_b64_tr_b16 v[142:143], v24 offset:17408
ds_read_b64_tr_b16 v[144:145], v25 offset:16384
ds_read_b64_tr_b16 v[146:147], v25 offset:17408
s_waitcnt lgkmcnt(6)
v_mfma_f32_16x16x32_bf16 v[148:151], v[128:131], v[132:135], v[148:151]
s_waitcnt lgkmcnt(4)
v_mfma_f32_16x16x32_bf16 v[152:155], v[128:131], v[136:139], v[152:155]
s_waitcnt lgkmcnt(2)
v_mfma_f32_16x16x32_bf16 v[156:159], v[128:131], v[140:143], v[156:159]
s_waitcnt lgkmcnt(0)
v_mfma_f32_16x16x32_bf16 v[160:163], v[128:131], v[144:147], v[160:163]
s_barrier
s_waitcnt vmcnt(5)
s_add_u32 m0, s10, 0
s_add_u32 s14, s59, 262144
buffer_load_dwordx4 v18, s[36:39], s14 offen offset:0 nt lds
s_waitcnt vmcnt(5)
buffer_load_dwordx4 v19, s[36:39], s14 offen offset:1024 nt lds
s_waitcnt vmcnt(5)
buffer_load_dwordx4 v20, s[36:39], s14 offen offset:2048 nt lds
s_waitcnt vmcnt(5)
buffer_load_dwordx4 v21, s[36:39], s14 offen offset:3072 nt lds
ds_read_b128 v[128:131], v26 offset:832
ds_read_b64_tr_b16 v[132:133], v22 offset:20480
ds_read_b64_tr_b16 v[134:135], v22 offset:21504
ds_read_b64_tr_b16 v[136:137], v23 offset:20480
ds_read_b64_tr_b16 v[138:139], v23 offset:21504
ds_read_b64_tr_b16 v[140:141], v24 offset:20480
ds_read_b64_tr_b16 v[142:143], v24 offset:21504
ds_read_b64_tr_b16 v[144:145], v25 offset:20480
ds_read_b64_tr_b16 v[146:147], v25 offset:21504
s_waitcnt lgkmcnt(6)
v_mfma_f32_16x16x32_bf16 v[148:151], v[128:131], v[132:135], v[148:151]
s_waitcnt lgkmcnt(4)
v_mfma_f32_16x16x32_bf16 v[152:155], v[128:131], v[136:139], v[152:155]
s_waitcnt lgkmcnt(2)
v_mfma_f32_16x16x32_bf16 v[156:159], v[128:131], v[140:143], v[156:159]
s_waitcnt lgkmcnt(0)
v_mfma_f32_16x16x32_bf16 v[160:163], v[128:131], v[144:147], v[160:163]
s_waitcnt vmcnt(5)
s_add_u32 m0, s10, 4096
s_add_u32 s14, s59, 278528
buffer_load_dwordx4 v18, s[36:39], s14 offen offset:0 nt lds
s_waitcnt vmcnt(5)
buffer_load_dwordx4 v19, s[36:39], s14 offen offset:1024 nt lds
s_waitcnt vmcnt(5)
buffer_load_dwordx4 v20, s[36:39], s14 offen offset:2048 nt lds
s_waitcnt vmcnt(5)
buffer_load_dwordx4 v21, s[36:39], s14 offen offset:3072 nt lds
ds_read_b128 v[128:131], v26 offset:896
ds_read_b64_tr_b16 v[132:133], v22 offset:24576
ds_read_b64_tr_b16 v[134:135], v22 offset:25600
ds_read_b64_tr_b16 v[136:137], v23 offset:24576
ds_read_b64_tr_b16 v[138:139], v23 offset:25600
ds_read_b64_tr_b16 v[140:141], v24 offset:24576
ds_read_b64_tr_b16 v[142:143], v24 offset:25600
ds_read_b64_tr_b16 v[144:145], v25 offset:24576
ds_read_b64_tr_b16 v[146:147], v25 offset:25600
s_waitcnt lgkmcnt(6)
v_mfma_f32_16x16x32_bf16 v[148:151], v[128:131], v[132:135], v[148:151]
s_waitcnt lgkmcnt(4)
v_mfma_f32_16x16x32_bf16 v[152:155], v[128:131], v[136:139], v[152:155]
s_waitcnt lgkmcnt(2)
v_mfma_f32_16x16x32_bf16 v[156:159], v[128:131], v[140:143], v[156:159]
s_waitcnt lgkmcnt(0)
v_mfma_f32_16x16x32_bf16 v[160:163], v[128:131], v[144:147], v[160:163]
s_waitcnt vmcnt(5)
s_add_u32 m0, s10, 8192
s_add_u32 s14, s59, 294912
buffer_load_dwordx4 v18, s[36:39], s14 offen offset:0 nt lds
s_waitcnt vmcnt(5)
buffer_load_dwordx4 v19, s[36:39], s14 offen offset:1024 nt lds
s_waitcnt vmcnt(5)
buffer_load_dwordx4 v20, s[36:39], s14 offen offset:2048 nt lds
s_waitcnt vmcnt(5)
buffer_load_dwordx4 v21, s[36:39], s14 offen offset:3072 nt lds
ds_read_b128 v[128:131], v26 offset:960
ds_read_b64_tr_b16 v[132:133], v22 offset:28672
ds_read_b64_tr_b16 v[134:135], v22 offset:29696
ds_read_b64_tr_b16 v[136:137], v23 offset:28672
ds_read_b64_tr_b16 v[138:139], v23 offset:29696
ds_read_b64_tr_b16 v[140:141], v24 offset:28672
ds_read_b64_tr_b16 v[142:143], v24 offset:29696
ds_read_b64_tr_b16 v[144:145], v25 offset:28672
ds_read_b64_tr_b16 v[146:147], v25 offset:29696
s_waitcnt lgkmcnt(6)
v_mfma_f32_16x16x32_bf16 v[148:151], v[128:131], v[132:135], v[148:151]
s_waitcnt lgkmcnt(4)
v_mfma_f32_16x16x32_bf16 v[152:155], v[128:131], v[136:139], v[152:155]
s_waitcnt lgkmcnt(2)
v_mfma_f32_16x16x32_bf16 v[156:159], v[128:131], v[140:143], v[156:159]
s_waitcnt lgkmcnt(0)
v_mfma_f32_16x16x32_bf16 v[160:163], v[128:131], v[144:147], v[160:163]
s_waitcnt vmcnt(5)
s_add_u32 m0, s10, 12288
s_add_u32 s14, s59, 311296
buffer_load_dwordx4 v18, s[36:39], s14 offen offset:0 nt lds
s_waitcnt vmcnt(5)
buffer_load_dwordx4 v19, s[36:39], s14 offen offset:1024 nt lds
s_waitcnt vmcnt(5)
buffer_load_dwordx4 v20, s[36:39], s14 offen offset:2048 nt lds
s_waitcnt vmcnt(5)
buffer_load_dwordx4 v21, s[36:39], s14 offen offset:3072 nt lds
ds_read_b128 v[128:131], v26 offset:1024
ds_read_b64_tr_b16 v[132:133], v22 offset:0
ds_read_b64_tr_b16 v[134:135], v22 offset:1024
ds_read_b64_tr_b16 v[136:137], v23 offset:0
ds_read_b64_tr_b16 v[138:139], v23 offset:1024
ds_read_b64_tr_b16 v[140:141], v24 offset:0
ds_read_b64_tr_b16 v[142:143], v24 offset:1024
ds_read_b64_tr_b16 v[144:145], v25 offset:0
ds_read_b64_tr_b16 v[146:147], v25 offset:1024
s_waitcnt lgkmcnt(6)
v_mfma_f32_16x16x32_bf16 v[148:151], v[128:131], v[132:135], v[148:151]
s_waitcnt lgkmcnt(4)
v_mfma_f32_16x16x32_bf16 v[152:155], v[128:131], v[136:139], v[152:155]
s_waitcnt lgkmcnt(2)
v_mfma_f32_16x16x32_bf16 v[156:159], v[128:131], v[140:143], v[156:159]
s_waitcnt lgkmcnt(0)
v_mfma_f32_16x16x32_bf16 v[160:163], v[128:131], v[144:147], v[160:163]
s_waitcnt vmcnt(5)
s_add_u32 m0, s10, 16384
s_add_u32 s14, s59, 327680
buffer_load_dwordx4 v18, s[36:39], s14 offen offset:0 nt lds
s_waitcnt vmcnt(5)
buffer_load_dwordx4 v19, s[36:39], s14 offen offset:1024 nt lds
s_waitcnt vmcnt(5)
buffer_load_dwordx4 v20, s[36:39], s14 offen offset:2048 nt lds
s_waitcnt vmcnt(5)
buffer_load_dwordx4 v21, s[36:39], s14 offen offset:3072 nt lds
ds_read_b128 v[128:131], v26 offset:1088
ds_read_b64_tr_b16 v[132:133], v22 offset:4096
ds_read_b64_tr_b16 v[134:135], v22 offset:5120
ds_read_b64_tr_b16 v[136:137], v23 offset:4096
ds_read_b64_tr_b16 v[138:139], v23 offset:5120
ds_read_b64_tr_b16 v[140:141], v24 offset:4096
ds_read_b64_tr_b16 v[142:143], v24 offset:5120
ds_read_b64_tr_b16 v[144:145], v25 offset:4096
ds_read_b64_tr_b16 v[146:147], v25 offset:5120
s_waitcnt lgkmcnt(6)
v_mfma_f32_16x16x32_bf16 v[148:151], v[128:131], v[132:135], v[148:151]
s_waitcnt lgkmcnt(4)
v_mfma_f32_16x16x32_bf16 v[152:155], v[128:131], v[136:139], v[152:155]
s_waitcnt lgkmcnt(2)
v_mfma_f32_16x16x32_bf16 v[156:159], v[128:131], v[140:143], v[156:159]
s_waitcnt lgkmcnt(0)
v_mfma_f32_16x16x32_bf16 v[160:163], v[128:131], v[144:147], v[160:163]
s_waitcnt vmcnt(5)
s_add_u32 m0, s10, 20480
s_add_u32 s14, s59, 344064
buffer_load_dwordx4 v18, s[36:39], s14 offen offset:0 nt lds
s_waitcnt vmcnt(5)
buffer_load_dwordx4 v19, s[36:39], s14 offen offset:1024 nt lds
s_waitcnt vmcnt(5)
buffer_load_dwordx4 v20, s[36:39], s14 offen offset:2048 nt lds
s_waitcnt vmcnt(5)
buffer_load_dwordx4 v21, s[36:39], s14 offen offset:3072 nt lds
ds_read_b128 v[128:131], v26 offset:1152
ds_read_b64_tr_b16 v[132:133], v22 offset:8192
ds_read_b64_tr_b16 v[134:135], v22 offset:9216
ds_read_b64_tr_b16 v[136:137], v23 offset:8192
ds_read_b64_tr_b16 v[138:139], v23 offset:9216
ds_read_b64_tr_b16 v[140:141], v24 offset:8192
ds_read_b64_tr_b16 v[142:143], v24 offset:9216
ds_read_b64_tr_b16 v[144:145], v25 offset:8192
ds_read_b64_tr_b16 v[146:147], v25 offset:9216
s_waitcnt lgkmcnt(6)
v_mfma_f32_16x16x32_bf16 v[148:151], v[128:131], v[132:135], v[148:151]
s_waitcnt lgkmcnt(4)
v_mfma_f32_16x16x32_bf16 v[152:155], v[128:131], v[136:139], v[152:155]
s_waitcnt lgkmcnt(2)
v_mfma_f32_16x16x32_bf16 v[156:159], v[128:131], v[140:143], v[156:159]
s_waitcnt lgkmcnt(0)
v_mfma_f32_16x16x32_bf16 v[160:163], v[128:131], v[144:147], v[160:163]
s_waitcnt vmcnt(5)
s_add_u32 m0, s10, 24576
s_add_u32 s14, s59, 360448
buffer_load_dwordx4 v18, s[36:39], s14 offen offset:0 nt lds
s_waitcnt vmcnt(5)
buffer_load_dwordx4 v19, s[36:39], s14 offen offset:1024 nt lds
s_waitcnt vmcnt(5)
buffer_load_dwordx4 v20, s[36:39], s14 offen offset:2048 nt lds
s_waitcnt vmcnt(5)
buffer_load_dwordx4 v21, s[36:39], s14 offen offset:3072 nt lds
ds_read_b128 v[128:131], v26 offset:1216
ds_read_b64_tr_b16 v[132:133], v22 offset:12288
ds_read_b64_tr_b16 v[134:135], v22 offset:13312
ds_read_b64_tr_b16 v[136:137], v23 offset:12288
ds_read_b64_tr_b16 v[138:139], v23 offset:13312
ds_read_b64_tr_b16 v[140:141], v24 offset:12288
ds_read_b64_tr_b16 v[142:143], v24 offset:13312
ds_read_b64_tr_b16 v[144:145], v25 offset:12288
ds_read_b64_tr_b16 v[146:147], v25 offset:13312
s_waitcnt lgkmcnt(6)
v_mfma_f32_16x16x32_bf16 v[148:151], v[128:131], v[132:135], v[148:151]
s_waitcnt lgkmcnt(4)
v_mfma_f32_16x16x32_bf16 v[152:155], v[128:131], v[136:139], v[152:155]
s_waitcnt lgkmcnt(2)
v_mfma_f32_16x16x32_bf16 v[156:159], v[128:131], v[140:143], v[156:159]
s_waitcnt lgkmcnt(0)
v_mfma_f32_16x16x32_bf16 v[160:163], v[128:131], v[144:147], v[160:163]
s_waitcnt vmcnt(5)
s_add_u32 m0, s10, 28672
s_add_u32 s14, s59, 376832
buffer_load_dwordx4 v18, s[36:39], s14 offen offset:0 nt lds
s_waitcnt vmcnt(5)
buffer_load_dwordx4 v19, s[36:39], s14 offen offset:1024 nt lds
s_waitcnt vmcnt(5)
buffer_load_dwordx4 v20, s[36:39], s14 offen offset:2048 nt lds
s_waitcnt vmcnt(5)
buffer_load_dwordx4 v21, s[36:39], s14 offen offset:3072 nt lds
ds_read_b128 v[128:131], v26 offset:1280
ds_read_b64_tr_b16 v[132:133], v22 offset:16384
ds_read_b64_tr_b16 v[134:135], v22 offset:17408
ds_read_b64_tr_b16 v[136:137], v23 offset:16384
ds_read_b64_tr_b16 v[138:139], v23 offset:17408
ds_read_b64_tr_b16 v[140:141], v24 offset:16384
ds_read_b64_tr_b16 v[142:143], v24 offset:17408
ds_read_b64_tr_b16 v[144:145], v25 offset:16384
ds_read_b64_tr_b16 v[146:147], v25 offset:17408
s_waitcnt lgkmcnt(6)
v_mfma_f32_16x16x32_bf16 v[148:151], v[128:131], v[132:135], v[148:151]
s_waitcnt lgkmcnt(4)
v_mfma_f32_16x16x32_bf16 v[152:155], v[128:131], v[136:139], v[152:155]
s_waitcnt lgkmcnt(2)
v_mfma_f32_16x16x32_bf16 v[156:159], v[128:131], v[140:143], v[156:159]
s_waitcnt lgkmcnt(0)
v_mfma_f32_16x16x32_bf16 v[160:163], v[128:131], v[144:147], v[160:163]
s_add_u32 m0, s10, 0
s_add_u32 s14, s59, 393216
buffer_load_dwordx4 v18, s[36:39], s14 offen offset:0 nt lds
buffer_load_dwordx4 v19, s[36:39], s14 offen offset:1024 nt lds
buffer_load_dwordx4 v20, s[36:39], s14 offen offset:2048 nt lds
s_waitcnt vmcnt(8)
buffer_load_dwordx4 v21, s[36:39], s14 offen offset:3072 nt lds
ds_read_b128 v[128:131], v26 offset:1344
ds_read_b64_tr_b16 v[132:133], v22 offset:20480
ds_read_b64_tr_b16 v[134:135], v22 offset:21504
ds_read_b64_tr_b16 v[136:137], v23 offset:20480
ds_read_b64_tr_b16 v[138:139], v23 offset:21504
ds_read_b64_tr_b16 v[140:141], v24 offset:20480
ds_read_b64_tr_b16 v[142:143], v24 offset:21504
ds_read_b64_tr_b16 v[144:145], v25 offset:20480
ds_read_b64_tr_b16 v[146:147], v25 offset:21504
s_waitcnt lgkmcnt(6)
v_mfma_f32_16x16x32_bf16 v[148:151], v[128:131], v[132:135], v[148:151]
s_waitcnt lgkmcnt(4)
v_mfma_f32_16x16x32_bf16 v[152:155], v[128:131], v[136:139], v[152:155]
s_waitcnt lgkmcnt(2)
v_mfma_f32_16x16x32_bf16 v[156:159], v[128:131], v[140:143], v[156:159]
s_waitcnt lgkmcnt(0)
v_mfma_f32_16x16x32_bf16 v[160:163], v[128:131], v[144:147], v[160:163]
s_waitcnt vmcnt(8)
s_add_u32 m0, s10, 4096
s_add_u32 s14, s59, 409600
buffer_load_dwordx4 v18, s[36:39], s14 offen offset:0 nt lds
s_waitcnt vmcnt(8)
buffer_load_dwordx4 v19, s[36:39], s14 offen offset:1024 nt lds
s_waitcnt vmcnt(8)
buffer_load_dwordx4 v20, s[36:39], s14 offen offset:2048 nt lds
s_waitcnt vmcnt(8)
buffer_load_dwordx4 v21, s[36:39], s14 offen offset:3072 nt lds
ds_read_b128 v[128:131], v26 offset:1408
ds_read_b64_tr_b16 v[132:133], v22 offset:24576
ds_read_b64_tr_b16 v[134:135], v22 offset:25600
ds_read_b64_tr_b16 v[136:137], v23 offset:24576
ds_read_b64_tr_b16 v[138:139], v23 offset:25600
ds_read_b64_tr_b16 v[140:141], v24 offset:24576
ds_read_b64_tr_b16 v[142:143], v24 offset:25600
ds_read_b64_tr_b16 v[144:145], v25 offset:24576
ds_read_b64_tr_b16 v[146:147], v25 offset:25600
s_waitcnt lgkmcnt(6)
v_mfma_f32_16x16x32_bf16 v[148:151], v[128:131], v[132:135], v[148:151]
s_waitcnt lgkmcnt(4)
v_mfma_f32_16x16x32_bf16 v[152:155], v[128:131], v[136:139], v[152:155]
s_waitcnt lgkmcnt(2)
v_mfma_f32_16x16x32_bf16 v[156:159], v[128:131], v[140:143], v[156:159]
s_waitcnt lgkmcnt(0)
v_mfma_f32_16x16x32_bf16 v[160:163], v[128:131], v[144:147], v[160:163]
s_waitcnt vmcnt(8)
s_add_u32 m0, s10, 8192
s_add_u32 s14, s59, 425984
buffer_load_dwordx4 v18, s[36:39], s14 offen offset:0 nt lds
s_waitcnt vmcnt(8)
buffer_load_dwordx4 v19, s[36:39], s14 offen offset:1024 nt lds
s_waitcnt vmcnt(8)
buffer_load_dwordx4 v20, s[36:39], s14 offen offset:2048 nt lds
s_waitcnt vmcnt(8)
buffer_load_dwordx4 v21, s[36:39], s14 offen offset:3072 nt lds
ds_read_b128 v[128:131], v26 offset:1472
ds_read_b64_tr_b16 v[132:133], v22 offset:28672
ds_read_b64_tr_b16 v[134:135], v22 offset:29696
ds_read_b64_tr_b16 v[136:137], v23 offset:28672
ds_read_b64_tr_b16 v[138:139], v23 offset:29696
ds_read_b64_tr_b16 v[140:141], v24 offset:28672
ds_read_b64_tr_b16 v[142:143], v24 offset:29696
ds_read_b64_tr_b16 v[144:145], v25 offset:28672
ds_read_b64_tr_b16 v[146:147], v25 offset:29696
s_waitcnt lgkmcnt(6)
v_mfma_f32_16x16x32_bf16 v[148:151], v[128:131], v[132:135], v[148:151]
s_waitcnt lgkmcnt(4)
v_mfma_f32_16x16x32_bf16 v[152:155], v[128:131], v[136:139], v[152:155]
s_waitcnt lgkmcnt(2)
v_mfma_f32_16x16x32_bf16 v[156:159], v[128:131], v[140:143], v[156:159]
s_waitcnt lgkmcnt(0)
v_mfma_f32_16x16x32_bf16 v[160:163], v[128:131], v[144:147], v[160:163]
s_waitcnt vmcnt(8)
s_add_u32 m0, s10, 12288
s_add_u32 s14, s59, 442368
buffer_load_dwordx4 v18, s[36:39], s14 offen offset:0 nt lds
s_waitcnt vmcnt(8)
buffer_load_dwordx4 v19, s[36:39], s14 offen offset:1024 nt lds
s_waitcnt vmcnt(8)
buffer_load_dwordx4 v20, s[36:39], s14 offen offset:2048 nt lds
s_waitcnt vmcnt(8)
buffer_load_dwordx4 v21, s[36:39], s14 offen offset:3072 nt lds
ds_read_b128 v[128:131], v26 offset:1536
ds_read_b64_tr_b16 v[132:133], v22 offset:0
ds_read_b64_tr_b16 v[134:135], v22 offset:1024
ds_read_b64_tr_b16 v[136:137], v23 offset:0
ds_read_b64_tr_b16 v[138:139], v23 offset:1024
ds_read_b64_tr_b16 v[140:141], v24 offset:0
ds_read_b64_tr_b16 v[142:143], v24 offset:1024
ds_read_b64_tr_b16 v[144:145], v25 offset:0
ds_read_b64_tr_b16 v[146:147], v25 offset:1024
s_waitcnt lgkmcnt(6)
v_mfma_f32_16x16x32_bf16 v[148:151], v[128:131], v[132:135], v[148:151]
s_waitcnt lgkmcnt(4)
v_mfma_f32_16x16x32_bf16 v[152:155], v[128:131], v[136:139], v[152:155]
s_waitcnt lgkmcnt(2)
v_mfma_f32_16x16x32_bf16 v[156:159], v[128:131], v[140:143], v[156:159]
s_waitcnt lgkmcnt(0)
v_mfma_f32_16x16x32_bf16 v[160:163], v[128:131], v[144:147], v[160:163]
s_waitcnt vmcnt(8)
s_add_u32 m0, s10, 16384
s_add_u32 s14, s59, 458752
buffer_load_dwordx4 v18, s[36:39], s14 offen offset:0 nt lds
s_waitcnt vmcnt(8)
buffer_load_dwordx4 v19, s[36:39], s14 offen offset:1024 nt lds
s_waitcnt vmcnt(8)
buffer_load_dwordx4 v20, s[36:39], s14 offen offset:2048 nt lds
s_waitcnt vmcnt(8)
buffer_load_dwordx4 v21, s[36:39], s14 offen offset:3072 nt lds
ds_read_b128 v[128:131], v26 offset:1600
ds_read_b64_tr_b16 v[132:133], v22 offset:4096
ds_read_b64_tr_b16 v[134:135], v22 offset:5120
ds_read_b64_tr_b16 v[136:137], v23 offset:4096
ds_read_b64_tr_b16 v[138:139], v23 offset:5120
ds_read_b64_tr_b16 v[140:141], v24 offset:4096
ds_read_b64_tr_b16 v[142:143], v24 offset:5120
ds_read_b64_tr_b16 v[144:145], v25 offset:4096
ds_read_b64_tr_b16 v[146:147], v25 offset:5120
s_waitcnt lgkmcnt(6)
v_mfma_f32_16x16x32_bf16 v[148:151], v[128:131], v[132:135], v[148:151]
s_waitcnt lgkmcnt(4)
v_mfma_f32_16x16x32_bf16 v[152:155], v[128:131], v[136:139], v[152:155]
s_waitcnt lgkmcnt(2)
v_mfma_f32_16x16x32_bf16 v[156:159], v[128:131], v[140:143], v[156:159]
s_waitcnt lgkmcnt(0)
v_mfma_f32_16x16x32_bf16 v[160:163], v[128:131], v[144:147], v[160:163]
s_waitcnt vmcnt(8)
s_add_u32 m0, s10, 20480
s_add_u32 s14, s59, 475136
buffer_load_dwordx4 v18, s[36:39], s14 offen offset:0 nt lds
s_waitcnt vmcnt(8)
buffer_load_dwordx4 v19, s[36:39], s14 offen offset:1024 nt lds
s_waitcnt vmcnt(8)
buffer_load_dwordx4 v20, s[36:39], s14 offen offset:2048 nt lds
s_waitcnt vmcnt(8)
buffer_load_dwordx4 v21, s[36:39], s14 offen offset:3072 nt lds
ds_read_b128 v[128:131], v26 offset:1664
ds_read_b64_tr_b16 v[132:133], v22 offset:8192
ds_read_b64_tr_b16 v[134:135], v22 offset:9216
ds_read_b64_tr_b16 v[136:137], v23 offset:8192
ds_read_b64_tr_b16 v[138:139], v23 offset:9216
ds_read_b64_tr_b16 v[140:141], v24 offset:8192
ds_read_b64_tr_b16 v[142:143], v24 offset:9216
ds_read_b64_tr_b16 v[144:145], v25 offset:8192
ds_read_b64_tr_b16 v[146:147], v25 offset:9216
s_waitcnt lgkmcnt(6)
v_mfma_f32_16x16x32_bf16 v[148:151], v[128:131], v[132:135], v[148:151]
s_waitcnt lgkmcnt(4)
v_mfma_f32_16x16x32_bf16 v[152:155], v[128:131], v[136:139], v[152:155]
s_waitcnt lgkmcnt(2)
v_mfma_f32_16x16x32_bf16 v[156:159], v[128:131], v[140:143], v[156:159]
s_waitcnt lgkmcnt(0)
v_mfma_f32_16x16x32_bf16 v[160:163], v[128:131], v[144:147], v[160:163]
s_waitcnt vmcnt(8)
s_add_u32 m0, s10, 24576
s_add_u32 s14, s59, 491520
buffer_load_dwordx4 v18, s[36:39], s14 offen offset:0 nt lds
s_waitcnt vmcnt(8)
buffer_load_dwordx4 v19, s[36:39], s14 offen offset:1024 nt lds
s_waitcnt vmcnt(8)
buffer_load_dwordx4 v20, s[36:39], s14 offen offset:2048 nt lds
s_waitcnt vmcnt(8)
buffer_load_dwordx4 v21, s[36:39], s14 offen offset:3072 nt lds
ds_read_b128 v[128:131], v26 offset:1728
ds_read_b64_tr_b16 v[132:133], v22 offset:12288
ds_read_b64_tr_b16 v[134:135], v22 offset:13312
ds_read_b64_tr_b16 v[136:137], v23 offset:12288
ds_read_b64_tr_b16 v[138:139], v23 offset:13312
ds_read_b64_tr_b16 v[140:141], v24 offset:12288
ds_read_b64_tr_b16 v[142:143], v24 offset:13312
ds_read_b64_tr_b16 v[144:145], v25 offset:12288
ds_read_b64_tr_b16 v[146:147], v25 offset:13312
s_waitcnt lgkmcnt(6)
v_mfma_f32_16x16x32_bf16 v[148:151], v[128:131], v[132:135], v[148:151]
s_waitcnt lgkmcnt(4)
v_mfma_f32_16x16x32_bf16 v[152:155], v[128:131], v[136:139], v[152:155]
s_waitcnt lgkmcnt(2)
v_mfma_f32_16x16x32_bf16 v[156:159], v[128:131], v[140:143], v[156:159]
s_waitcnt lgkmcnt(0)
v_mfma_f32_16x16x32_bf16 v[160:163], v[128:131], v[144:147], v[160:163]
s_waitcnt vmcnt(8)
s_add_u32 m0, s10, 28672
s_add_u32 s14, s59, 507904
buffer_load_dwordx4 v18, s[36:39], s14 offen offset:0 nt lds
s_waitcnt vmcnt(8)
buffer_load_dwordx4 v19, s[36:39], s14 offen offset:1024 nt lds
s_waitcnt vmcnt(8)
buffer_load_dwordx4 v20, s[36:39], s14 offen offset:2048 nt lds
s_waitcnt vmcnt(8)
buffer_load_dwordx4 v21, s[36:39], s14 offen offset:3072 nt lds
ds_read_b128 v[128:131], v26 offset:1792
ds_read_b64_tr_b16 v[132:133], v22 offset:16384
ds_read_b64_tr_b16 v[134:135], v22 offset:17408
ds_read_b64_tr_b16 v[136:137], v23 offset:16384
ds_read_b64_tr_b16 v[138:139], v23 offset:17408
ds_read_b64_tr_b16 v[140:141], v24 offset:16384
ds_read_b64_tr_b16 v[142:143], v24 offset:17408
ds_read_b64_tr_b16 v[144:145], v25 offset:16384
ds_read_b64_tr_b16 v[146:147], v25 offset:17408
s_waitcnt lgkmcnt(6)
v_mfma_f32_16x16x32_bf16 v[148:151], v[128:131], v[132:135], v[148:151]
s_waitcnt lgkmcnt(4)
v_mfma_f32_16x16x32_bf16 v[152:155], v[128:131], v[136:139], v[152:155]
s_waitcnt lgkmcnt(2)
v_mfma_f32_16x16x32_bf16 v[156:159], v[128:131], v[140:143], v[156:159]
s_waitcnt lgkmcnt(0)
v_mfma_f32_16x16x32_bf16 v[160:163], v[128:131], v[144:147], v[160:163]
v_mov_b32 v31, 149136
ds_read_b32 v31, v31
s_waitcnt lgkmcnt(0)
v_readfirstlane_b32 s57, v31
s_waitcnt vmcnt(8)
ds_read_b128 v[128:131], v26 offset:1856
ds_read_b64_tr_b16 v[132:133], v22 offset:20480
ds_read_b64_tr_b16 v[134:135], v22 offset:21504
ds_read_b64_tr_b16 v[136:137], v23 offset:20480
ds_read_b64_tr_b16 v[138:139], v23 offset:21504
ds_read_b64_tr_b16 v[140:141], v24 offset:20480
ds_read_b64_tr_b16 v[142:143], v24 offset:21504
ds_read_b64_tr_b16 v[144:145], v25 offset:20480
ds_read_b64_tr_b16 v[146:147], v25 offset:21504
s_waitcnt lgkmcnt(6)
v_mfma_f32_16x16x32_bf16 v[148:151], v[128:131], v[132:135], v[148:151]
s_waitcnt lgkmcnt(4)
v_mfma_f32_16x16x32_bf16 v[152:155], v[128:131], v[136:139], v[152:155]
s_waitcnt lgkmcnt(2)
v_mfma_f32_16x16x32_bf16 v[156:159], v[128:131], v[140:143], v[156:159]
s_waitcnt lgkmcnt(0)
v_mfma_f32_16x16x32_bf16 v[160:163], v[128:131], v[144:147], v[160:163]
s_lshl_b32 s12, s8, 2
s_add_u32 s12, s12, s3
s_lshl_b32 s12, s12, 2
s_add_u32 s12, s12, s7
s_lshl_b32 s12, s12, 10
s_add_u32 s12, s12, 262144
v_lshlrev_b32 v28, 4, v1
v_add_u32 v28, s12, v28
s_mov_b32 s40, 0xffff0000
s_mov_b32 s41, 0
s_mov_b32 s42, 0
s_mov_b32 s43, 0x0000ffff
s_mov_b32 s44, 0
s_mov_b32 s45, 0xffff0000
v_mov_b32 v169, s9
v_mov_b32 v171, s9
s_waitcnt vmcnt(4)
ds_read_b128 v[128:131], v26 offset:1920
ds_read_b64_tr_b16 v[132:133], v22 offset:24576
ds_read_b64_tr_b16 v[134:135], v22 offset:25600
ds_read_b64_tr_b16 v[136:137], v23 offset:24576
ds_read_b64_tr_b16 v[138:139], v23 offset:25600
ds_read_b64_tr_b16 v[140:141], v24 offset:24576
ds_read_b64_tr_b16 v[142:143], v24 offset:25600
ds_read_b64_tr_b16 v[144:145], v25 offset:24576
ds_read_b64_tr_b16 v[146:147], v25 offset:25600
s_waitcnt lgkmcnt(6)
v_mfma_f32_16x16x32_bf16 v[148:151], v[128:131], v[132:135], v[148:151]
s_waitcnt lgkmcnt(4)
v_mfma_f32_16x16x32_bf16 v[152:155], v[128:131], v[136:139], v[152:155]
s_waitcnt lgkmcnt(2)
v_mfma_f32_16x16x32_bf16 v[156:159], v[128:131], v[140:143], v[156:159]
s_waitcnt lgkmcnt(0)
v_mfma_f32_16x16x32_bf16 v[160:163], v[128:131], v[144:147], v[160:163]
s_waitcnt vmcnt(0)
ds_read_b128 v[128:131], v26 offset:1984
ds_read_b64_tr_b16 v[132:133], v22 offset:28672
ds_read_b64_tr_b16 v[134:135], v22 offset:29696
ds_read_b64_tr_b16 v[136:137], v23 offset:28672
ds_read_b64_tr_b16 v[138:139], v23 offset:29696
ds_read_b64_tr_b16 v[140:141], v24 offset:28672
ds_read_b64_tr_b16 v[142:143], v24 offset:29696
ds_read_b64_tr_b16 v[144:145], v25 offset:28672
ds_read_b64_tr_b16 v[146:147], v25 offset:29696
s_waitcnt lgkmcnt(6)
v_mfma_f32_16x16x32_bf16 v[148:151], v[128:131], v[132:135], v[148:151]
s_waitcnt lgkmcnt(4)
v_mfma_f32_16x16x32_bf16 v[152:155], v[128:131], v[136:139], v[152:155]
s_waitcnt lgkmcnt(2)
v_mfma_f32_16x16x32_bf16 v[156:159], v[128:131], v[140:143], v[156:159]
s_waitcnt lgkmcnt(0)
v_mfma_f32_16x16x32_bf16 v[160:163], v[128:131], v[144:147], v[160:163]
s_nop 7
v_cndmask_b32 v168, v148, v152, s[40:41]
v_cndmask_b32 v170, v149, v153, s[40:41]
v_cndmask_b32 v168, v168, v156, s[42:43]
v_cndmask_b32 v170, v170, v157, s[42:43]
v_cndmask_b32 v168, v168, v160, s[44:45]
v_cndmask_b32 v170, v170, v161, s[44:45]
s_cmp_eq_u32 s57, 1
s_cbranch_scc1 L_pub_local
global_store_dwordx4 v28, v[168:171], s[30:31] sc1
s_branch L_pub_done
L_pub_local:
global_store_dwordx4 v28, v[168:171], s[30:31]
L_pub_done:
s_barrier
s_endpgm
L_helper:
s_sub_u32 s3, s3, 4
v_and_b32 v2, 15, v1
v_lshrrev_b32 v3, 4, v1
s_waitcnt lgkmcnt(0)
s_cmp_lg_u32 s3, 0
s_cbranch_scc0 L_w4
s_barrier
s_branch L_h_b1
L_w4:
s_setprio 3
s_load_dword s9, s[30:31], 0
s_mov_b32 s32, s22
s_mov_b32 s33, s23
s_mov_b32 s34, 3670016
s_mov_b32 s35, 0x20000
s_mov_b32 s36, s16
s_mov_b32 s37, s17
s_mov_b32 s38, 7168
s_mov_b32 s39, 0x20000
s_lshl_b32 s10, s56, 5
s_add_u32 s10, s10, s4
v_lshrrev_b32 v4, 1, v1
v_lshlrev_b32 v4, 13, v4
v_and_b32 v5, 1, v1
v_lshl_add_u32 v4, v5, 4, v4
s_lshl_b32 s11, s10, 5
v_add_u32 v4, s11, v4
s_mov_b32 m0, 131072
s_mov_b32 s12, 0
buffer_load_dwordx4 v4, s[32:35], s12 offen  lds
s_mov_b32 m0, 132096
s_mov_b32 s12, 262144
buffer_load_dwordx4 v4, s[32:35], s12 offen  lds
s_mov_b32 m0, 133120
s_mov_b32 s12, 524288
buffer_load_dwordx4 v4, s[32:35], s12 offen  lds
s_mov_b32 m0, 134144
s_mov_b32 s12, 786432
buffer_load_dwordx4 v4, s[32:35], s12 offen  lds
s_mov_b32 m0, 135168
s_mov_b32 s12, 1048576
buffer_load_dwordx4 v4, s[32:35], s12 offen  lds
s_mov_b32 m0, 136192
s_mov_b32 s12, 1310720
buffer_load_dwordx4 v4, s[32:35], s12 offen  lds
s_mov_b32 m0, 137216
s_mov_b32 s12, 1572864
buffer_load_dwordx4 v4, s[32:35], s12 offen  lds
s_mov_b32 m0, 138240
s_mov_b32 s12, 1835008
s_waitcnt vmcnt(6)
buffer_load_dwordx4 v4, s[32:35], s12 offen  lds
s_mov_b32 m0, 139264
s_mov_b32 s12, 2097152
s_waitcnt vmcnt(6)
buffer_load_dwordx4 v4, s[32:35], s12 offen  lds
s_mov_b32 m0, 140288
s_mov_b32 s12, 2359296
s_waitcnt vmcnt(6)
buffer_load_dwordx4 v4, s[32:35], s12 offen  lds
s_mov_b32 m0, 141312
s_mov_b32 s12, 2621440
s_waitcnt vmcnt(6)
buffer_load_dwordx4 v4, s[32:35], s12 offen  lds
s_mov_b32 m0, 142336
s_mov_b32 s12, 2883584
s_waitcnt vmcnt(6)
buffer_load_dwordx4 v4, s[32:35], s12 offen  lds
s_mov_b32 m0, 143360
s_mov_b32 s12, 3145728
s_waitcnt vmcnt(6)
buffer_load_dwordx4 v4, s[32:35], s12 offen  lds
s_mov_b32 m0, 144384
s_mov_b32 s12, 3407872
s_waitcnt vmcnt(6)
buffer_load_dwordx4 v4, s[32:35], s12 offen  lds
v_and_b32 v5, 7, v2
v_mul_u32_u24 v5, 896, v5
v_lshl_add_u32 v5, v3, 4, v5
v_lshrrev_b32 v6, 3, v2
v_lshl_add_u32 v5, v6, 6, v5
buffer_load_dwordx4 v[8:11], v5, s[36:39], 0 offen offset:0
buffer_load_dwordx4 v[12:15], v5, s[36:39], 0 offen offset:128
buffer_load_dwordx4 v[16:19], v5, s[36:39], 0 offen offset:256
buffer_load_dwordx4 v[20:23], v5, s[36:39], 0 offen offset:384
buffer_load_dwordx4 v[24:27], v5, s[36:39], 0 offen offset:512
buffer_load_dwordx4 v[28:31], v5, s[36:39], 0 offen offset:640
buffer_load_dwordx4 v[32:35], v5, s[36:39], 0 offen offset:768
v_lshlrev_b32 v6, 8, v3
v_lshl_add_u32 v6, v2, 3, v6
v_add_u32 v6, 131072, v6
v_lshlrev_b32 v7, 14, v2
v_lshl_add_u32 v7, v3, 4, v7
s_lshl_b32 s11, s10, 6
s_add_u32 s11, s11, 3145728
v_add_u32 v7, s11, v7
s_waitcnt vmcnt(0) lgkmcnt(0)
s_add_u32 s9, s9, 0x9e3779b9
ds_read_b64_tr_b16 v[40:41], v6 offset:0
ds_read_b64_tr_b16 v[42:43], v6 offset:128
ds_read_b64_tr_b16 v[44:45], v6 offset:1024
ds_read_b64_tr_b16 v[46:47], v6 offset:1152
ds_read_b64_tr_b16 v[48:49], v6 offset:2048
ds_read_b64_tr_b16 v[50:51], v6 offset:2176
s_waitcnt lgkmcnt(4)
v_mfma_f32_16x16x32_bf16 v[72:75], v[40:43], v[8:11], 0
ds_read_b64_tr_b16 v[52:53], v6 offset:3072
ds_read_b64_tr_b16 v[54:55], v6 offset:3200
s_waitcnt lgkmcnt(4)
v_mfma_f32_16x16x32_bf16 v[76:79], v[44:47], v[8:11], 0
ds_read_b64_tr_b16 v[40:41], v6 offset:4096
ds_read_b64_tr_b16 v[42:43], v6 offset:4224
s_waitcnt lgkmcnt(4)
v_mfma_f32_16x16x32_bf16 v[72:75], v[48:51], v[12:15], v[72:75]
ds_read_b64_tr_b16 v[44:45], v6 offset:5120
ds_read_b64_tr_b16 v[46:47], v6 offset:5248
s_waitcnt lgkmcnt(4)
v_mfma_f32_16x16x32_bf16 v[76:79], v[52:55], v[12:15], v[76:79]
ds_read_b64_tr_b16 v[48:49], v6 offset:6144
ds_read_b64_tr_b16 v[50:51], v6 offset:6272
s_waitcnt lgkmcnt(4)
v_mfma_f32_16x16x32_bf16 v[72:75], v[40:43], v[16:19], v[72:75]
ds_read_b64_tr_b16 v[52:53], v6 offset:7168
ds_read_b64_tr_b16 v[54:55], v6 offset:7296
s_waitcnt lgkmcnt(4)
v_mfma_f32_16x16x32_bf16 v[76:79], v[44:47], v[16:19], v[76:79]
ds_read_b64_tr_b16 v[40:41], v6 offset:8192
ds_read_b64_tr_b16 v[42:43], v6 offset:8320
s_waitcnt lgkmcnt(4)
v_mfma_f32_16x16x32_bf16 v[72:75], v[48:51], v[20:23], v[72:75]
ds_read_b64_tr_b16 v[44:45], v6 offset:9216
ds_read_b64_tr_b16 v[46:47], v6 offset:9344
s_waitcnt lgkmcnt(4)
v_mfma_f32_16x16x32_bf16 v[76:79], v[52:55], v[20:23], v[76:79]
ds_read_b64_tr_b16 v[48:49], v6 offset:10240
ds_read_b64_tr_b16 v[50:51], v6 offset:10368
s_waitcnt lgkmcnt(4)
v_mfma_f32_16x16x32_bf16 v[72:75], v[40:43], v[24:27], v[72:75]
ds_read_b64_tr_b16 v[52:53], v6 offset:11264
ds_read_b64_tr_b16 v[54:55], v6 offset:11392
s_waitcnt lgkmcnt(4)
v_mfma_f32_16x16x32_bf16 v[76:79], v[44:47], v[24:27], v[76:79]
ds_read_b64_tr_b16 v[40:41], v6 offset:12288
ds_read_b64_tr_b16 v[42:43], v6 offset:12416
s_waitcnt lgkmcnt(4)
v_mfma_f32_16x16x32_bf16 v[72:75], v[48:51], v[28:31], v[72:75]
ds_read_b64_tr_b16 v[44:45], v6 offset:13312
ds_read_b64_tr_b16 v[46:47], v6 offset:13440
s_waitcnt lgkmcnt(4)
v_mfma_f32_16x16x32_bf16 v[76:79], v[52:55], v[28:31], v[76:79]
s_waitcnt lgkmcnt(2)
v_mfma_f32_16x16x32_bf16 v[72:75], v[40:43], v[32:35], v[72:75]
s_waitcnt lgkmcnt(0)
v_mfma_f32_16x16x32_bf16 v[76:79], v[44:47], v[32:35], v[76:79]
v_mov_b32 v81, s9
v_mov_b32 v83, s9
s_nop 7
v_add_f32_dpp v72, v76, v72 row_ror:8 row_mask:0xf bank_mask:0xf
v_add_f32_dpp v73, v77, v73 row_ror:8 row_mask:0xf bank_mask:0xf
v_add_f32_dpp v74, v78, v74 row_ror:8 row_mask:0xf bank_mask:0xf
v_add_f32_dpp v75, v79, v75 row_ror:8 row_mask:0xf bank_mask:0xf
v_cvt_pk_bf16_f32 v80, v72, v73
v_cvt_pk_bf16_f32 v82, v74, v75
s_mov_b32 exec_lo, 0x00ff00ff
s_mov_b32 exec_hi, 0x00ff00ff
global_store_dwordx4 v7, v[80:83], s[30:31] sc1
s_mov_b64 exec, -1
s_lshl_b32 s11, s6, 14
s_lshl_b32 s12, s5, 11
s_add_u32 s11, s11, s12
s_add_u32 s11, s11, 3145728
v_lshlrev_b32 v7, 4, v1
v_add_u32 v7, s11, v7
s_mov_b32 s13, 0
s_barrier
L_pollq:
global_load_dwordx4 v[84:87], v7, s[30:31] sc1
global_load_dwordx4 v[88:91], v7, s[30:31] offset:1024 sc1
s_waitcnt vmcnt(0)
s_mov_b64 s[40:41], 0
v_cmp_ne_u32 vcc, s9, v85
s_or_b64 s[40:41], s[40:41], vcc
v_cmp_ne_u32 vcc, s9, v87
s_or_b64 s[40:41], s[40:41], vcc
v_cmp_ne_u32 vcc, s9, v89
s_or_b64 s[40:41], s[40:41], vcc
v_cmp_ne_u32 vcc, s9, v91
s_or_b64 s[40:41], s[40:41], vcc
s_cmp_eq_u64 s[40:41], 0
s_cbranch_scc1 L_pollq_done
s_add_u32 s13, s13, 1
s_cmp_gt_u32 s13, 200000
s_cbranch_scc1 L_pollq_done
s_branch L_pollq
L_pollq_done:
v_mov_b32 v85, v86
v_mov_b32 v89, v90
v_lshlrev_b32 v7, 3, v1
v_add_u32 v7, 147456, v7
ds_write_b64 v7, v[84:85]
ds_write_b64 v7, v[88:89] offset:512
L_noq:
v_mov_b32 v8, 148736
v_mov_b32 v9, s9
ds_write_b32 v8, v9
v_mov_b32 v8, 149136
v_mov_b32 v10, 0
ds_write_b32 v8, v10
s_waitcnt lgkmcnt(0)
s_setprio 0
L_h_b1:
s_barrier
v_mov_b32 v8, 148736
ds_read_b32 v8, v8
s_waitcnt lgkmcnt(0)
v_readfirstlane_b32 s9, v8
s_mov_b32 s32, s24
s_mov_b32 s33, s25
s_mov_b32 s34, 3670016
s_mov_b32 s35, 0x20000
v_mul_u32_u24 v47, 7168, v3
v_lshl_add_u32 v47, v2, 4, v47
s_lshl_b32 s10, s3, 8
v_add_u32 v47, s10, v47
s_cmp_eq_u32 s3, 3
s_cselect_b32 s12, 0x7fffffff, 0
v_mov_b32 v9, s12
v_cmp_lt_u32 vcc, 7, v2
s_nop 1
v_cndmask_b32 v9, 0, v9, vcc
v_or_b32 v47, v47, v9
s_lshl_b32 s54, s5, 9
s_lshl_b32 s11, s7, 6
s_add_u32 s54, s54, s11
s_mul_i32 s54, s54, 896
s_mov_b32 s46, 0x05040100
s_mov_b32 s47, 0x07060302
s_setprio 3
s_add_u32 s12, s54, 0
buffer_load_dwordx4 v[96:99], v47, s[32:35], s12 offen
s_add_u32 s12, s54, 896
buffer_load_dwordx4 v[100:103], v47, s[32:35], s12 offen
s_add_u32 s12, s54, 1792
buffer_load_dwordx4 v[104:107], v47, s[32:35], s12 offen
s_add_u32 s12, s54, 2688
buffer_load_dwordx4 v[108:111], v47, s[32:35], s12 offen
s_setprio 0
s_waitcnt vmcnt(0)
s_setprio 3
s_add_u32 s12, s54, 3584
buffer_load_dwordx4 v[112:115], v47, s[32:35], s12 offen
s_add_u32 s12, s54, 4480
buffer_load_dwordx4 v[116:119], v47, s[32:35], s12 offen
s_add_u32 s12, s54, 5376
buffer_load_dwordx4 v[120:123], v47, s[32:35], s12 offen
s_add_u32 s12, s54, 6272
buffer_load_dwordx4 v[124:127], v47, s[32:35], s12 offen
s_setprio 0
s_waitcnt vmcnt(0)
v_perm_b32 v128, v100, v96, s46
v_perm_b32 v129, v108, v104, s46
v_perm_b32 v130, v116, v112, s46
v_perm_b32 v131, v124, v120, s46
v_perm_b32 v132, v100, v96, s47
v_perm_b32 v133, v108, v104, s47
v_perm_b32 v134, v116, v112, s47
v_perm_b32 v135, v124, v120, s47
v_perm_b32 v136, v101, v97, s46
v_perm_b32 v137, v109, v105, s46
v_perm_b32 v138, v117, v113, s46
v_perm_b32 v139, v125, v121, s46
v_perm_b32 v140, v101, v97, s47
v_perm_b32 v141, v109, v105, s47
v_perm_b32 v142, v117, v113, s47
v_perm_b32 v143, v125, v121, s47
v_perm_b32 v144, v102, v98, s46
v_perm_b32 v145, v110, v106, s46
v_perm_b32 v146, v118, v114, s46
v_perm_b32 v147, v126, v122, s46
v_perm_b32 v148, v102, v98, s47
v_perm_b32 v149, v110, v106, s47
v_perm_b32 v150, v118, v114, s47
v_perm_b32 v151, v126, v122, s47
v_perm_b32 v152, v103, v99, s46
v_perm_b32 v153, v111, v107, s46
v_perm_b32 v154, v119, v115, s46
v_perm_b32 v155, v127, v123, s46
v_perm_b32 v156, v103, v99, s47
v_perm_b32 v157, v111, v107, s47
v_perm_b32 v158, v119, v115, s47
v_perm_b32 v159, v127, v123, s47
s_setprio 3
s_add_u32 s12, s54, 28672
buffer_load_dwordx4 v[96:99], v47, s[32:35], s12 offen
s_add_u32 s12, s54, 29568
buffer_load_dwordx4 v[100:103], v47, s[32:35], s12 offen
s_add_u32 s12, s54, 30464
buffer_load_dwordx4 v[104:107], v47, s[32:35], s12 offen
s_add_u32 s12, s54, 31360
buffer_load_dwordx4 v[108:111], v47, s[32:35], s12 offen
s_setprio 0
s_waitcnt vmcnt(0)
s_setprio 3
s_add_u32 s12, s54, 32256
buffer_load_dwordx4 v[112:115], v47, s[32:35], s12 offen
s_add_u32 s12, s54, 33152
buffer_load_dwordx4 v[116:119], v47, s[32:35], s12 offen
s_add_u32 s12, s54, 34048
buffer_load_dwordx4 v[120:123], v47, s[32:35], s12 offen
s_add_u32 s12, s54, 34944
buffer_load_dwordx4 v[124:127], v47, s[32:35], s12 offen
s_setprio 0
s_waitcnt vmcnt(0)
v_perm_b32 v160, v100, v96, s46
v_perm_b32 v161, v108, v104, s46
v_perm_b32 v162, v116, v112, s46
v_perm_b32 v163, v124, v120, s46
v_perm_b32 v164, v100, v96, s47
v_perm_b32 v165, v108, v104, s47
v_perm_b32 v166, v116, v112, s47
v_perm_b32 v167, v124, v120, s47
v_perm_b32 v168, v101, v97, s46
v_perm_b32 v169, v109, v105, s46
v_perm_b32 v170, v117, v113, s46
v_perm_b32 v171, v125, v121, s46
v_perm_b32 v172, v101, v97, s47
v_perm_b32 v173, v109, v105, s47
v_perm_b32 v174, v117, v113, s47
v_perm_b32 v175, v125, v121, s47
v_perm_b32 v176, v102, v98, s46
v_perm_b32 v177, v110, v106, s46
v_perm_b32 v178, v118, v114, s46
v_perm_b32 v179, v126, v122, s46
v_perm_b32 v180, v102, v98, s47
v_perm_b32 v181, v110, v106, s47
v_perm_b32 v182, v118, v114, s47
v_perm_b32 v183, v126, v122, s47
v_perm_b32 v184, v103, v99, s46
v_perm_b32 v185, v111, v107, s46
v_perm_b32 v186, v119, v115, s46
v_perm_b32 v187, v127, v123, s46
v_perm_b32 v188, v103, v99, s47
v_perm_b32 v189, v111, v107, s47
v_perm_b32 v190, v119, v115, s47
v_perm_b32 v191, v127, v123, s47
s_barrier
s_barrier
s_cmp_lg_u32 s3, 0
s_cbranch_scc1 L_h_wo2
v_and_b32 v4, 1, v2
v_lshlrev_b32 v4, 6, v4
v_add_u32 v4, 148480, v4
ds_read_b128 v[8:11], v4 offset:0
ds_read_b128 v[12:15], v4 offset:16
ds_read_b128 v[16:19], v4 offset:32
ds_read_b128 v[20:23], v4 offset:48
ds_read_b128 v[24:27], v4 offset:128
ds_read_b128 v[28:31], v4 offset:144
ds_read_b128 v[32:35], v4 offset:160
ds_read_b128 v[36:39], v4 offset:176
s_waitcnt lgkmcnt(0)
v_max3_f32 v40, v8, v9, v10
v_max3_f32 v40, v40, v11, v12
v_max3_f32 v40, v40, v13, v14
v_max3_f32 v40, v40, v15, v16
v_max3_f32 v40, v40, v17, v18
v_max3_f32 v40, v40, v19, v20
v_max3_f32 v40, v40, v21, v22
v_max_f32 v40, v40, v23
v_add_f32 v42, v24, v25
v_add_f32 v42, v42, v26
v_add_f32 v42, v42, v27
v_add_f32 v42, v42, v28
v_add_f32 v42, v42, v29
v_add_f32 v42, v42, v30
v_add_f32 v42, v42, v31
v_add_f32 v42, v42, v32
v_add_f32 v42, v42, v33
v_add_f32 v42, v42, v34
v_add_f32 v42, v42, v35
v_add_f32 v42, v42, v36
v_add_f32 v42, v42, v37
v_add_f32 v42, v42, v38
v_add_f32 v42, v42, v39
v_mov_b32 v41, s9
v_mov_b32 v43, s9
s_getreg_b32 s60, hwreg(HW_REG_XCC_ID)
s_and_b32 s60, s60, 15
v_mov_b32 v44, s60
s_mov_b64 s[40:41], 4
v_cndmask_b32 v40, v40, v44, s[40:41]
v_cndmask_b32 v42, v42, v44, s[40:41]
s_lshl_b32 s10, s8, 2
s_add_u32 s10, s10, s7
s_lshl_b32 s12, s10, 6
s_add_u32 s12, s12, 196608
v_lshlrev_b32 v5, 4, v1
v_add_u32 v6, s12, v5
s_mov_b64 exec, 7
global_store_dwordx4 v6, v[40:43], s[30:31] sc1
s_mov_b64 exec, -1
s_setprio 3
s_add_u32 s12, s54, 229376
buffer_load_dwordx4 v[96:99], v47, s[32:35], s12 offen
s_add_u32 s12, s54, 230272
buffer_load_dwordx4 v[100:103], v47, s[32:35], s12 offen
s_add_u32 s12, s54, 231168
buffer_load_dwordx4 v[104:107], v47, s[32:35], s12 offen
s_add_u32 s12, s54, 232064
buffer_load_dwordx4 v[108:111], v47, s[32:35], s12 offen
s_setprio 0
s_waitcnt vmcnt(0)
s_setprio 3
s_add_u32 s12, s54, 232960
buffer_load_dwordx4 v[112:115], v47, s[32:35], s12 offen
s_add_u32 s12, s54, 233856
buffer_load_dwordx4 v[116:119], v47, s[32:35], s12 offen
s_add_u32 s12, s54, 234752
buffer_load_dwordx4 v[120:123], v47, s[32:35], s12 offen
s_add_u32 s12, s54, 235648
buffer_load_dwordx4 v[124:127], v47, s[32:35], s12 offen
s_setprio 0
s_waitcnt vmcnt(0)
v_perm_b32 v192, v100, v96, s46
v_perm_b32 v193, v108, v104, s46
v_perm_b32 v194, v116, v112, s46
v_perm_b32 v195, v124, v120, s46
v_perm_b32 v196, v100, v96, s47
v_perm_b32 v197, v108, v104, s47
v_perm_b32 v198, v116, v112, s47
v_perm_b32 v199, v124, v120, s47
v_perm_b32 v200, v101, v97, s46
v_perm_b32 v201, v109, v105, s46
v_perm_b32 v202, v117, v113, s46
v_perm_b32 v203, v125, v121, s46
v_perm_b32 v204, v101, v97, s47
v_perm_b32 v205, v109, v105, s47
v_perm_b32 v206, v117, v113, s47
v_perm_b32 v207, v125, v121, s47
v_perm_b32 v208, v102, v98, s46
v_perm_b32 v209, v110, v106, s46
v_perm_b32 v210, v118, v114, s46
v_perm_b32 v211, v126, v122, s46
v_perm_b32 v212, v102, v98, s47
v_perm_b32 v213, v110, v106, s47
v_perm_b32 v214, v118, v114, s47
v_perm_b32 v215, v126, v122, s47
v_perm_b32 v216, v103, v99, s46
v_perm_b32 v217, v111, v107, s46
v_perm_b32 v218, v119, v115, s46
v_perm_b32 v219, v127, v123, s46
v_perm_b32 v220, v103, v99, s47
v_perm_b32 v221, v111, v107, s47
v_perm_b32 v222, v119, v115, s47
v_perm_b32 v223, v127, v123, s47
s_barrier
s_lshl_b32 s10, s8, 8
s_add_u32 s10, s10, 196608
v_and_b32 v5, 3, v1
v_cmp_eq_u32 vcc, 3, v5
s_nop 1
v_cndmask_b32 v5, v5, 1, vcc
v_lshlrev_b32 v5, 4, v5
v_add_u32 v5, s10, v5
s_mov_b32 s13, 0
L_polls:
global_load_dwordx4 v[8:11], v5, s[30:31] offset:0 sc1
global_load_dwordx4 v[12:15], v5, s[30:31] offset:64 sc1
global_load_dwordx4 v[16:19], v5, s[30:31] offset:128 sc1
global_load_dwordx4 v[20:23], v5, s[30:31] offset:192 sc1
s_waitcnt vmcnt(0)
s_mov_b64 s[40:41], 0
v_cmp_ne_u32 vcc, s9, v9
s_or_b64 s[40:41], s[40:41], vcc
v_cmp_ne_u32 vcc, s9, v11
s_or_b64 s[40:41], s[40:41], vcc
v_cmp_ne_u32 vcc, s9, v13
s_or_b64 s[40:41], s[40:41], vcc
v_cmp_ne_u32 vcc, s9, v15
s_or_b64 s[40:41], s[40:41], vcc
v_cmp_ne_u32 vcc, s9, v17
s_or_b64 s[40:41], s[40:41], vcc
v_cmp_ne_u32 vcc, s9, v19
s_or_b64 s[40:41], s[40:41], vcc
v_cmp_ne_u32 vcc, s9, v21
s_or_b64 s[40:41], s[40:41], vcc
v_cmp_ne_u32 vcc, s9, v23
s_or_b64 s[40:41], s[40:41], vcc
s_cmp_eq_u64 s[40:41], 0
s_cbranch_scc1 L_polls_done
s_add_u32 s13, s13, 1
s_cmp_gt_u32 s13, 200000
s_cbranch_scc1 L_polls_done
s_sleep 8
s_branch L_polls
L_polls_done:
v_cmp_ne_u32 s[40:41], s60, v8
v_cmp_ne_u32 s[42:43], s60, v12
s_or_b64 s[40:41], s[40:41], s[42:43]
v_cmp_ne_u32 s[42:43], s60, v16
s_or_b64 s[40:41], s[40:41], s[42:43]
v_cmp_ne_u32 s[42:43], s60, v20
s_or_b64 s[40:41], s[40:41], s[42:43]
s_and_b32 s40, s40, 4
s_cmp_eq_u32 s40, 0
s_cselect_b32 s40, 1, 0
s_cmp_gt_u32 s13, 200000
s_cselect_b32 s40, 0, s40
v_mov_b32 v33, 149136
v_mov_b32 v34, s40
ds_write_b32 v33, v34
v_max3_f32 v24, v8, v12, v16
v_max_f32 v24, v24, v20
s_mov_b32 s15, 0x3db8aa3b
v_sub_f32 v26, v8, v24
v_mul_f32 v26, s15, v26
v_sub_f32 v27, v12, v24
v_mul_f32 v27, s15, v27
v_sub_f32 v28, v16, v24
v_mul_f32 v28, s15, v28
v_sub_f32 v29, v20, v24
v_mul_f32 v29, s15, v29
v_exp_f32 v26, v26
v_exp_f32 v27, v27
v_exp_f32 v28, v28
v_exp_f32 v29, v29
s_nop 0
v_mul_f32 v30, v26, v10
v_fmac_f32 v30, v27, v14
v_fmac_f32 v30, v28, v18
v_fmac_f32 v30, v29, v22
v_rcp_f32 v31, v30
s_nop 0
v_fma_f32 v32, -v30, v31, 2.0
v_mul_f32 v31, v31, v32
v_mul_f32 v26, v26, v31
v_mul_f32 v27, v27, v31
v_mul_f32 v28, v28, v31
v_mul_f32 v29, v29, v31
s_nop 1
v_mov_b32_dpp v48, v26 quad_perm:[0,0,0,0] row_mask:0xf bank_mask:0xf
v_mov_b32_dpp v52, v26 quad_perm:[1,1,1,1] row_mask:0xf bank_mask:0xf
v_mov_b32_dpp v49, v27 quad_perm:[0,0,0,0] row_mask:0xf bank_mask:0xf
v_mov_b32_dpp v53, v27 quad_perm:[1,1,1,1] row_mask:0xf bank_mask:0xf
v_mov_b32_dpp v50, v28 quad_perm:[0,0,0,0] row_mask:0xf bank_mask:0xf
v_mov_b32_dpp v54, v28 quad_perm:[1,1,1,1] row_mask:0xf bank_mask:0xf
v_mov_b32_dpp v51, v29 quad_perm:[0,0,0,0] row_mask:0xf bank_mask:0xf
v_mov_b32_dpp v55, v29 quad_perm:[1,1,1,1] row_mask:0xf bank_mask:0xf
s_setprio 3
s_add_u32 s12, s54, 258048
buffer_load_dwordx4 v[96:99], v47, s[32:35], s12 offen
s_add_u32 s12, s54, 258944
buffer_load_dwordx4 v[100:103], v47, s[32:35], s12 offen
s_add_u32 s12, s54, 259840
buffer_load_dwordx4 v[104:107], v47, s[32:35], s12 offen
s_add_u32 s12, s54, 260736
buffer_load_dwordx4 v[108:111], v47, s[32:35], s12 offen
s_setprio 0
s_waitcnt vmcnt(0)
s_setprio 3
s_add_u32 s12, s54, 261632
buffer_load_dwordx4 v[112:115], v47, s[32:35], s12 offen
s_add_u32 s12, s54, 262528
buffer_load_dwordx4 v[116:119], v47, s[32:35], s12 offen
s_add_u32 s12, s54, 263424
buffer_load_dwordx4 v[120:123], v47, s[32:35], s12 offen
s_add_u32 s12, s54, 264320
buffer_load_dwordx4 v[124:127], v47, s[32:35], s12 offen
s_setprio 0
s_waitcnt vmcnt(0)
v_perm_b32 v224, v100, v96, s46
v_perm_b32 v225, v108, v104, s46
v_perm_b32 v226, v116, v112, s46
v_perm_b32 v227, v124, v120, s46
v_perm_b32 v228, v100, v96, s47
v_perm_b32 v229, v108, v104, s47
v_perm_b32 v230, v116, v112, s47
v_perm_b32 v231, v124, v120, s47
v_perm_b32 v232, v101, v97, s46
v_perm_b32 v233, v109, v105, s46
v_perm_b32 v234, v117, v113, s46
v_perm_b32 v235, v125, v121, s46
v_perm_b32 v236, v101, v97, s47
v_perm_b32 v237, v109, v105, s47
v_perm_b32 v238, v117, v113, s47
v_perm_b32 v239, v125, v121, s47
v_perm_b32 v240, v102, v98, s46
v_perm_b32 v241, v110, v106, s46
v_perm_b32 v242, v118, v114, s46
v_perm_b32 v243, v126, v122, s46
v_perm_b32 v244, v102, v98, s47
v_perm_b32 v245, v110, v106, s47
v_perm_b32 v246, v118, v114, s47
v_perm_b32 v247, v126, v122, s47
v_perm_b32 v248, v103, v99, s46
v_perm_b32 v249, v111, v107, s46
v_perm_b32 v250, v119, v115, s46
v_perm_b32 v251, v127, v123, s46
v_perm_b32 v252, v103, v99, s47
v_perm_b32 v253, v111, v107, s47
v_perm_b32 v254, v119, v115, s47
v_perm_b32 v255, v127, v123, s47
s_branch L_h_b4
L_h_wo2:
s_setprio 3
s_add_u32 s12, s54, 229376
buffer_load_dwordx4 v[96:99], v47, s[32:35], s12 offen
s_add_u32 s12, s54, 230272
buffer_load_dwordx4 v[100:103], v47, s[32:35], s12 offen
s_add_u32 s12, s54, 231168
buffer_load_dwordx4 v[104:107], v47, s[32:35], s12 offen
s_add_u32 s12, s54, 232064
buffer_load_dwordx4 v[108:111], v47, s[32:35], s12 offen
s_setprio 0
s_waitcnt vmcnt(0)
s_setprio 3
s_add_u32 s12, s54, 232960
buffer_load_dwordx4 v[112:115], v47, s[32:35], s12 offen
s_add_u32 s12, s54, 233856
buffer_load_dwordx4 v[116:119], v47, s[32:35], s12 offen
s_add_u32 s12, s54, 234752
buffer_load_dwordx4 v[120:123], v47, s[32:35], s12 offen
s_add_u32 s12, s54, 235648
buffer_load_dwordx4 v[124:127], v47, s[32:35], s12 offen
s_setprio 0
s_waitcnt vmcnt(0)
v_perm_b32 v192, v100, v96, s46
v_perm_b32 v193, v108, v104, s46
v_perm_b32 v194, v116, v112, s46
v_perm_b32 v195, v124, v120, s46
v_perm_b32 v196, v100, v96, s47
v_perm_b32 v197, v108, v104, s47
v_perm_b32 v198, v116, v112, s47
v_perm_b32 v199, v124, v120, s47
v_perm_b32 v200, v101, v97, s46
v_perm_b32 v201, v109, v105, s46
v_perm_b32 v202, v117, v113, s46
v_perm_b32 v203, v125, v121, s46
v_perm_b32 v204, v101, v97, s47
v_perm_b32 v205, v109, v105, s47
v_perm_b32 v206, v117, v113, s47
v_perm_b32 v207, v125, v121, s47
v_perm_b32 v208, v102, v98, s46
v_perm_b32 v209, v110, v106, s46
v_perm_b32 v210, v118, v114, s46
v_perm_b32 v211, v126, v122, s46
v_perm_b32 v212, v102, v98, s47
v_perm_b32 v213, v110, v106, s47
v_perm_b32 v214, v118, v114, s47
v_perm_b32 v215, v126, v122, s47
v_perm_b32 v216, v103, v99, s46
v_perm_b32 v217, v111, v107, s46
v_perm_b32 v218, v119, v115, s46
v_perm_b32 v219, v127, v123, s46
v_perm_b32 v220, v103, v99, s47
v_perm_b32 v221, v111, v107, s47
v_perm_b32 v222, v119, v115, s47
v_perm_b32 v223, v127, v123, s47
s_setprio 3
s_add_u32 s12, s54, 258048
buffer_load_dwordx4 v[96:99], v47, s[32:35], s12 offen
s_add_u32 s12, s54, 258944
buffer_load_dwordx4 v[100:103], v47, s[32:35], s12 offen
s_add_u32 s12, s54, 259840
buffer_load_dwordx4 v[104:107], v47, s[32:35], s12 offen
s_add_u32 s12, s54, 260736
buffer_load_dwordx4 v[108:111], v47, s[32:35], s12 offen
s_setprio 0
s_waitcnt vmcnt(0)
s_setprio 3
s_add_u32 s12, s54, 261632
buffer_load_dwordx4 v[112:115], v47, s[32:35], s12 offen
s_add_u32 s12, s54, 262528
buffer_load_dwordx4 v[116:119], v47, s[32:35], s12 offen
s_add_u32 s12, s54, 263424
buffer_load_dwordx4 v[120:123], v47, s[32:35], s12 offen
s_add_u32 s12, s54, 264320
buffer_load_dwordx4 v[124:127], v47, s[32:35], s12 offen
s_setprio 0
s_waitcnt vmcnt(0)
v_perm_b32 v224, v100, v96, s46
v_perm_b32 v225, v108, v104, s46
v_perm_b32 v226, v116, v112, s46
v_perm_b32 v227, v124, v120, s46
v_perm_b32 v228, v100, v96, s47
v_perm_b32 v229, v108, v104, s47
v_perm_b32 v230, v116, v112, s47
v_perm_b32 v231, v124, v120, s47
v_perm_b32 v232, v101, v97, s46
v_perm_b32 v233, v109, v105, s46
v_perm_b32 v234, v117, v113, s46
v_perm_b32 v235, v125, v121, s46
v_perm_b32 v236, v101, v97, s47
v_perm_b32 v237, v109, v105, s47
v_perm_b32 v238, v117, v113, s47
v_perm_b32 v239, v125, v121, s47
v_perm_b32 v240, v102, v98, s46
v_perm_b32 v241, v110, v106, s46
v_perm_b32 v242, v118, v114, s46
v_perm_b32 v243, v126, v122, s46
v_perm_b32 v244, v102, v98, s47
v_perm_b32 v245, v110, v106, s47
v_perm_b32 v246, v118, v114, s47
v_perm_b32 v247, v126, v122, s47
v_perm_b32 v248, v103, v99, s46
v_perm_b32 v249, v111, v107, s46
v_perm_b32 v250, v119, v115, s46
v_perm_b32 v251, v127, v123, s46
v_perm_b32 v252, v103, v99, s47
v_perm_b32 v253, v111, v107, s47
v_perm_b32 v254, v119, v115, s47
v_perm_b32 v255, v127, v123, s47
s_barrier
L_h_b4:
s_lshl_b32 s10, s8, 2
s_add_u32 s10, s10, s7
s_lshl_b32 s10, s10, 12
s_add_u32 s10, s10, 262144
v_lshlrev_b32 v5, 4, v1
v_add_u32 v5, s10, v5
v_lshlrev_b32 v6, 1, v1
v_add_u32 v6, 148800, v6
v_lshlrev_b32 v7, 4, v3
v_add_u32 v7, 148800, v7
s_lshl_b32 s11, s5, 2
s_add_u32 s11, s11, s7
s_mul_i32 s12, s6, 28
s_lshl_b32 s13, s3, 3
s_add_u32 s12, s12, s13
s_lshl_b32 s12, s12, 5
s_add_u32 s12, s12, s11
s_lshl_b32 s12, s12, 7
s_add_u32 s12, s12, 1310720
v_lshrrev_b32 v44, 1, v2
v_lshlrev_b32 v44, 12, v44
v_and_b32 v45, 1, v2
v_lshl_add_u32 v45, v45, 2, v3
v_lshl_add_u32 v44, v45, 4, v44
v_add_u32 v44, s12, v44
s_mul_i32 s12, s6, 28
s_add_u32 s12, s12, s11
s_lshl_b32 s12, s12, 12
s_add_u32 s12, s12, 1310720
v_lshlrev_b32 v46, 4, v1
v_add_u32 v46, s12, v46
s_mov_b32 s48, 0xffff0000
s_mov_b32 s49, 0
s_mov_b32 s50, 0
s_mov_b32 s51, 0x0000ffff
s_mov_b32 s52, 0
s_mov_b32 s53, 0xffff0000
s_barrier
s_cmp_lg_u32 s3, 0
s_cbranch_scc1 L_h_b5
s_mov_b32 s13, 0
global_load_dwordx4 v[96:99], v5, s[30:31] offset:0 sc1
global_load_dwordx4 v[100:103], v5, s[30:31] offset:1024 sc1
global_load_dwordx4 v[104:107], v5, s[30:31] offset:2048 sc1
global_load_dwordx4 v[108:111], v5, s[30:31] offset:3072 sc1
L_polla:
global_load_dwordx4 v[112:115], v5, s[30:31] offset:0 sc1
global_load_dwordx4 v[116:119], v5, s[30:31] offset:1024 sc1
global_load_dwordx4 v[120:123], v5, s[30:31] offset:2048 sc1
global_load_dwordx4 v[124:127], v5, s[30:31] offset:3072 sc1
s_waitcnt vmcnt(4)
v_min3_u32 v28, v97, v99, v101
v_max3_u32 v29, v97, v99, v101
v_min3_u32 v28, v28, v103, v105
v_max3_u32 v29, v29, v103, v105
v_min3_u32 v28, v28, v107, v109
v_max3_u32 v29, v29, v107, v109
v_min_u32 v28, v28, v111
v_max_u32 v29, v29, v111
v_cmp_ne_u32 s[40:41], s9, v28
v_cmp_ne_u32 vcc, s9, v29
s_or_b64 s[40:41], s[40:41], vcc
s_cmp_eq_u64 s[40:41], 0
s_cbranch_scc1 L_polla_a
global_load_dwordx4 v[96:99], v5, s[30:31] offset:0 sc1
global_load_dwordx4 v[100:103], v5, s[30:31] offset:1024 sc1
global_load_dwordx4 v[104:107], v5, s[30:31] offset:2048 sc1
global_load_dwordx4 v[108:111], v5, s[30:31] offset:3072 sc1
s_waitcnt vmcnt(4)
v_min3_u32 v28, v113, v115, v117
v_max3_u32 v29, v113, v115, v117
v_min3_u32 v28, v28, v119, v121
v_max3_u32 v29, v29, v119, v121
v_min3_u32 v28, v28, v123, v125
v_max3_u32 v29, v29, v123, v125
v_min_u32 v28, v28, v127
v_max_u32 v29, v29, v127
v_cmp_ne_u32 s[40:41], s9, v28
v_cmp_ne_u32 vcc, s9, v29
s_or_b64 s[40:41], s[40:41], vcc
s_cmp_eq_u64 s[40:41], 0
s_cbranch_scc1 L_polla_b
s_add_u32 s13, s13, 1
s_cmp_gt_u32 s13, 200000
s_cbranch_scc1 L_polla_b
s_branch L_polla
L_polla_a:
v_mul_f32 v24, v48, v96
v_mul_f32 v25, v52, v98
v_fmac_f32 v24, v49, v100
v_fmac_f32 v25, v53, v102
v_fmac_f32 v24, v50, v104
v_fmac_f32 v25, v54, v106
v_fmac_f32 v24, v51, v108
v_fmac_f32 v25, v55, v110
s_branch L_polla_done
L_polla_b:
v_mul_f32 v24, v48, v112
v_mul_f32 v25, v52, v114
v_fmac_f32 v24, v49, v116
v_fmac_f32 v25, v53, v118
v_fmac_f32 v24, v50, v120
v_fmac_f32 v25, v54, v122
v_fmac_f32 v24, v51, v124
v_fmac_f32 v25, v55, v126
L_polla_done:
v_cvt_pk_bf16_f32 v24, v24, v25
ds_write_b16 v6, v24
ds_write_b16_d16_hi v6, v24 offset:128
s_waitcnt lgkmcnt(0)
L_h_b5:
s_barrier
ds_read_b128 v[8:11], v7 offset:0
ds_read_b128 v[12:15], v7 offset:64
ds_read_b128 v[16:19], v7 offset:128
ds_read_b128 v[20:23], v7 offset:192
s_waitcnt lgkmcnt(3)
v_mfma_f32_16x16x32_bf16 v[56:59], v[8:11], v[128:131], 0
v_mfma_f32_16x16x32_bf16 v[60:63], v[8:11], v[132:135], 0
v_mfma_f32_16x16x32_bf16 v[64:67], v[8:11], v[136:139], 0
v_mfma_f32_16x16x32_bf16 v[68:71], v[8:11], v[140:143], 0
v_mfma_f32_16x16x32_bf16 v[72:75], v[8:11], v[144:147], 0
v_mfma_f32_16x16x32_bf16 v[76:79], v[8:11], v[148:151], 0
v_mfma_f32_16x16x32_bf16 v[80:83], v[8:11], v[152:155], 0
v_mfma_f32_16x16x32_bf16 v[84:87], v[8:11], v[156:159], 0
s_waitcnt lgkmcnt(2)
v_mfma_f32_16x16x32_bf16 v[56:59], v[12:15], v[160:163], v[56:59]
v_mfma_f32_16x16x32_bf16 v[60:63], v[12:15], v[164:167], v[60:63]
v_mfma_f32_16x16x32_bf16 v[64:67], v[12:15], v[168:171], v[64:67]
v_mfma_f32_16x16x32_bf16 v[68:71], v[12:15], v[172:175], v[68:71]
v_mfma_f32_16x16x32_bf16 v[72:75], v[12:15], v[176:179], v[72:75]
v_mfma_f32_16x16x32_bf16 v[76:79], v[12:15], v[180:183], v[76:79]
v_mfma_f32_16x16x32_bf16 v[80:83], v[12:15], v[184:187], v[80:83]
v_mfma_f32_16x16x32_bf16 v[84:87], v[12:15], v[188:191], v[84:87]
s_waitcnt lgkmcnt(1)
v_mfma_f32_16x16x32_bf16 v[56:59], v[16:19], v[192:195], v[56:59]
v_mfma_f32_16x16x32_bf16 v[60:63], v[16:19], v[196:199], v[60:63]
v_mfma_f32_16x16x32_bf16 v[64:67], v[16:19], v[200:203], v[64:67]
v_mfma_f32_16x16x32_bf16 v[68:71], v[16:19], v[204:207], v[68:71]
v_mfma_f32_16x16x32_bf16 v[72:75], v[16:19], v[208:211], v[72:75]
v_mfma_f32_16x16x32_bf16 v[76:79], v[16:19], v[212:215], v[76:79]
v_mfma_f32_16x16x32_bf16 v[80:83], v[16:19], v[216:219], v[80:83]
v_mfma_f32_16x16x32_bf16 v[84:87], v[16:19], v[220:223], v[84:87]
s_waitcnt lgkmcnt(0)
v_mfma_f32_16x16x32_bf16 v[56:59], v[20:23], v[224:227], v[56:59]
v_mfma_f32_16x16x32_bf16 v[60:63], v[20:23], v[228:231], v[60:63]
v_mfma_f32_16x16x32_bf16 v[64:67], v[20:23], v[232:235], v[64:67]
v_mfma_f32_16x16x32_bf16 v[68:71], v[20:23], v[236:239], v[68:71]
v_mfma_f32_16x16x32_bf16 v[72:75], v[20:23], v[240:243], v[72:75]
v_mfma_f32_16x16x32_bf16 v[76:79], v[20:23], v[244:247], v[76:79]
v_mfma_f32_16x16x32_bf16 v[80:83], v[20:23], v[248:251], v[80:83]
v_mfma_f32_16x16x32_bf16 v[84:87], v[20:23], v[252:255], v[84:87]
v_mov_b32 v25, s9
v_mov_b32 v27, s9
s_nop 7
v_cndmask_b32 v24, v56, v64, s[48:49]
v_cndmask_b32 v26, v60, v68, s[48:49]
v_cndmask_b32 v24, v24, v72, s[50:51]
v_cndmask_b32 v26, v26, v76, s[50:51]
v_cndmask_b32 v24, v24, v80, s[52:53]
v_cndmask_b32 v26, v26, v84, s[52:53]
s_cmp_eq_u32 s3, 3
s_cselect_b32 s12, 0x00ff00ff, -1
s_mov_b32 exec_lo, s12
s_mov_b32 exec_hi, s12
global_store_dwordx4 v44, v[24:27], s[30:31] sc1
s_mov_b64 exec, -1
s_cmp_lg_u32 s3, 0
s_cbranch_scc1 L_h_done
s_cmp_ge_u32 s11, 28
s_cbranch_scc1 L_h_done
s_mov_b32 s13, 0
global_load_dwordx4 v[96:99], v46, s[30:31] offset:0 sc1
global_load_dwordx4 v[100:103], v46, s[30:31] offset:1024 sc1
global_load_dwordx4 v[104:107], v46, s[30:31] offset:2048 sc1
global_load_dwordx4 v[108:111], v46, s[30:31] offset:3072 sc1
L_pollo:
global_load_dwordx4 v[112:115], v46, s[30:31] offset:0 sc1
global_load_dwordx4 v[116:119], v46, s[30:31] offset:1024 sc1
global_load_dwordx4 v[120:123], v46, s[30:31] offset:2048 sc1
global_load_dwordx4 v[124:127], v46, s[30:31] offset:3072 sc1
s_waitcnt vmcnt(4)
v_min3_u32 v28, v97, v99, v101
v_max3_u32 v29, v97, v99, v101
v_min3_u32 v28, v28, v103, v105
v_max3_u32 v29, v29, v103, v105
v_min3_u32 v28, v28, v107, v109
v_max3_u32 v29, v29, v107, v109
v_min_u32 v28, v28, v111
v_max_u32 v29, v29, v111
v_cmp_ne_u32 s[40:41], s9, v28
v_cmp_ne_u32 vcc, s9, v29
s_or_b64 s[40:41], s[40:41], vcc
s_cmp_eq_u64 s[40:41], 0
s_cbranch_scc1 L_pollo_a
global_load_dwordx4 v[96:99], v46, s[30:31] offset:0 sc1
global_load_dwordx4 v[100:103], v46, s[30:31] offset:1024 sc1
global_load_dwordx4 v[104:107], v46, s[30:31] offset:2048 sc1
global_load_dwordx4 v[108:111], v46, s[30:31] offset:3072 sc1
s_waitcnt vmcnt(4)
v_min3_u32 v28, v113, v115, v117
v_max3_u32 v29, v113, v115, v117
v_min3_u32 v28, v28, v119, v121
v_max3_u32 v29, v29, v119, v121
v_min3_u32 v28, v28, v123, v125
v_max3_u32 v29, v29, v123, v125
v_min_u32 v28, v28, v127
v_max_u32 v29, v29, v127
v_cmp_ne_u32 s[40:41], s9, v28
v_cmp_ne_u32 vcc, s9, v29
s_or_b64 s[40:41], s[40:41], vcc
s_cmp_eq_u64 s[40:41], 0
s_cbranch_scc1 L_pollo_b
s_add_u32 s13, s13, 1
s_cmp_gt_u32 s13, 200000
s_cbranch_scc1 L_pollo_b
s_branch L_pollo
L_pollo_a:
v_add_f32 v24, v96, v100
v_add_f32 v25, v98, v102
v_add_f32 v26, v104, v108
v_add_f32 v27, v106, v110
v_add_f32 v24, v24, v26
v_add_f32 v25, v25, v27
s_branch L_pollo_done
L_pollo_b:
v_add_f32 v24, v112, v116
v_add_f32 v25, v114, v118
v_add_f32 v26, v120, v124
v_add_f32 v27, v122, v126
v_add_f32 v24, v24, v26
v_add_f32 v25, v25, v27
L_pollo_done:
s_nop 1
v_add_f32_dpp v24, v24, v24 row_ror:8 row_mask:0xf bank_mask:0xf
v_add_f32_dpp v25, v25, v25 row_ror:8 row_mask:0xf bank_mask:0xf
v_mov_b32 v26, v24
v_mov_b32 v27, v25
s_nop 1
v_permlane16_swap_b32 v24, v26
v_permlane16_swap_b32 v25, v27
v_add_f32 v24, v24, v26
v_add_f32 v25, v25, v27
v_mov_b32 v26, v24
v_mov_b32 v27, v25
s_nop 1
v_permlane32_swap_b32 v24, v26
v_permlane32_swap_b32 v25, v27
v_add_f32 v24, v24, v26
v_add_f32 v25, v25, v27
v_cvt_pk_bf16_f32 v24, v24, v25
s_mul_i32 s12, s6, 896
s_lshl_b32 s13, s11, 5
s_add_u32 s12, s12, s13
v_lshlrev_b32 v26, 2, v1
v_add_u32 v26, s12, v26
s_mov_b64 exec, 0xff
global_store_dword v26, v24, s[26:27]
s_cmp_lg_u32 s2, 0
s_cbranch_scc1 L_h_done
s_mov_b64 exec, 1
v_mov_b32 v26, 0
v_mov_b32 v27, s9
global_store_dword v26, v27, s[30:31]
L_h_done:
L_end:
s_endpgm
.section .rodata,"a"
.p2align 6
.amdhsa_kernel standalone__gqa_block_cached__decode_kernel
  .amdhsa_next_free_vgpr 256
  .amdhsa_next_free_sgpr 96
  .amdhsa_accum_offset 256
  .amdhsa_group_segment_fixed_size 0
  .amdhsa_kernarg_size 64
  .amdhsa_user_sgpr_count 2
  .amdhsa_user_sgpr_kernarg_segment_ptr 1
  .amdhsa_system_sgpr_workgroup_id_x 1
  .amdhsa_float_denorm_mode_32 3
.end_amdhsa_kernel
```
